```python
import torch

def _softmax(x, axis=-1):
    return torch.softmax(x, dim=axis)
def _gelu(x):
    return torch.nn.functional.gelu(x, approximate="tanh")
def _silu(x):
    return torch.nn.functional.silu(x)
def _sigmoid(x):
    return torch.sigmoid(x)
def _layernorm(x, axis=-1, eps=1e-5):
    m = x.mean(dim=axis, keepdim=True)
    v = x.var(dim=axis, keepdim=True, unbiased=False)
    return (x - m) / torch.sqrt(v + eps)
def _scatter_add(tgt, idx, src, axis=0):
    return tgt.clone().index_add_(axis, idx, src)
def _segment_sum(src, seg, n):
    out = torch.zeros((n,) + src.shape[1:], dtype=src.dtype)
    return out.index_add_(0, seg, src)
def _pad(x, pw):
    flat = tuple(v for pair in reversed(pw) for v in pair)
    return torch.nn.functional.pad(x, flat)

kernel_name = 'interleave_layers__sliding_block_cached__dense_activation_gelu__decode'

def setup_inputs():

    _w = (lambda a: (lambda t: t.to(torch.bfloat16) if t.is_floating_point() else t)(torch.as_tensor(a)))
    def _A_setup():
        B, Sq, D = 2, 1, 576
        Hq, Hkv, Sk, Dh = 32, 16, 4096, 128
        assert Hq % Hkv == 0, (Hq, Hkv)
        return {
            "x": _w((lambda *s: torch.randn(*s, dtype=torch.bfloat16) * 0.05)(B, Sq, D)),
            "k_cache": _w((lambda *s: torch.randn(*s, dtype=torch.bfloat16) * 1.6)(B, Hkv, Sk, Dh)),
            "v_cache": _w((lambda *s: torch.randn(*s, dtype=torch.bfloat16) * 0.4)(B, Hkv, Sk, Dh)),
            "wq": _w((lambda *s: torch.randn(*s, dtype=torch.bfloat16) * 1.6)(D, Hq * Dh) * (D ** -0.5)),
            "wo": _w((lambda *s: torch.randn(*s, dtype=torch.bfloat16) * 0.4)(Hq * Dh, D) * ((Hq * Dh) ** -0.5)),
        }
    _A_in = _A_setup()

    def _B_setup():
        B, S, D, F = 2, 1, 576, 4608
        return {
            "x": _w((lambda *s: torch.randn(*s, dtype=torch.bfloat16) * 0.05)(B, S, D)),
            "w1": _w((lambda *s: torch.randn(*s, dtype=torch.bfloat16) * 0.4)(D, F) * (D ** -0.5)),
            "b1": _w((lambda *s: torch.randn(*s, dtype=torch.bfloat16) * 12.8)(F) * 0.01),
            "w2": _w((lambda *s: torch.randn(*s, dtype=torch.bfloat16) * 0.2)(F, D) * (F ** -0.5)),
            "b2": _w((lambda *s: torch.randn(*s, dtype=torch.bfloat16) * 0.8)(D) * 0.01),
        }
    _B_in = _B_setup()

    return {
        "A_x": _A_in["x"],
        "A_k_cache": _A_in["k_cache"],
        "A_v_cache": _A_in["v_cache"],
        "A_wq": _A_in["wq"],
        "A_wo": _A_in["wo"],
        "B_x": _B_in["x"],
        "B_w1": _B_in["w1"],
        "B_b1": _B_in["b1"],
        "B_w2": _B_in["w2"],
        "B_b2": _B_in["b2"],
    }

def reference(A_x, A_k_cache, A_v_cache, A_wq, A_wo, B_x, B_w1, B_b1, B_w2, B_b2):
    def _A_ref(x, k_cache, v_cache, wq, wo):
        B, Sq, D = x.shape
        Hq, Dh = 32, 128
        Hkv, Sk = k_cache.shape[1], k_cache.shape[2]
        W = min(4096, max(256, Sk // 4))
        rep = Hq // Hkv
        q = (lambda x, *d: x.permute(*d))((x @ wq).reshape(B, Sq, Hq, Dh), 0, 2, 1, 3)
        k = (lambda x, n, axis: torch.repeat_interleave(x, n, dim=axis))(k_cache[:, :, Sk - W:, :], rep, axis=1)
        v = (lambda x, n, axis: torch.repeat_interleave(x, n, dim=axis))(v_cache[:, :, Sk - W:, :], rep, axis=1)
        scores = torch.einsum("bhqd,bhkd->bhqk", q, k) * (Dh ** -0.5)
        p = _softmax(scores, axis=-1)
        o = torch.einsum("bhqk,bhkd->bhqd", p, v)
        return (lambda x, *d: x.permute(*d))(o, 0, 2, 1, 3).reshape(B, Sq, Hq * Dh) @ wo

    def _B_ref(x, w1, b1, w2, b2):
        h = torch.einsum("bsd,df->bsf", x, w1) + b1
        h = _gelu(h)
        return torch.einsum("bsf,fd->bsd", h, w2) + b2

    x = A_x
    x = x + _A_ref(_layernorm(x, axis=-1), A_k_cache, A_v_cache, A_wq, A_wo)
    x = x + _B_ref(_layernorm(x, axis=-1), B_w1, B_b1, B_w2, B_b2)
    x = x + _A_ref(_layernorm(x, axis=-1), A_k_cache, A_v_cache, A_wq, A_wo)
    x = x + _B_ref(_layernorm(x, axis=-1), B_w1, B_b1, B_w2, B_b2)
    return x
```

```asm
; @launch grid=(256,1,1) block=(256,1,1) lds=67584
.amdgcn_target "amdgcn-amd-amdhsa--gfx950"
.text
.globl interleave_layers__sliding_block_cached__dense_activation_gelu__decode_kernel
.p2align 8
.type interleave_layers__sliding_block_cached__dense_activation_gelu__decode_kernel,@function
interleave_layers__sliding_block_cached__dense_activation_gelu__decode_kernel:
    s_load_dwordx2 s[12:13], s[0:1], 24
    s_load_dwordx2 s[4:5], s[0:1], 8
    s_load_dwordx2 s[28:29], s[0:1], 96
    s_load_dwordx2 s[32:33], s[0:1], 0
    s_load_dwordx2 s[8:9], s[0:1], 16
    s_load_dwordx2 s[16:17], s[0:1], 32
    s_cmp_ge_u32 s2, 16
    s_cbranch_scc1 L_nc
    s_getpc_b64 s[66:67]
L_pc:
    v_lshlrev_b32 v160, 7, v0
    v_min_u32 v160, L_codeend-L_pc-4, v160
    global_load_dword v172, v160, s[66:67]
L_nc:
    s_cmp_ge_u32 s2, 256
    s_cbranch_scc1 L_end
    v_readfirstlane_b32 s52, v0
    v_lshrrev_b32 v158, 4, v0
    v_and_b32 v156, 15, v0
    v_lshlrev_b32 v158, 13, v158
    v_lshl_add_u32 v158, v156, 4, v158
    s_mov_b32 s14, 4718592
    s_mov_b32 s15, 0x20000
    s_and_b32 s53, s2, 7
    s_bfe_u32 s64, s2, 0x30003
    s_lshr_b32 s65, s2, 6
    s_lshl2_add_u32 s62, s53, s65
    s_lshl_b32 s65, s62, 8
    s_mul_i32 s57, s64, 589824
    s_add_u32 s57, s57, s65
    s_lshl4_add_u32 m0, s52, 49152
    v_and_b32 v0, 63, v0
    v_lshrrev_b32 v155, 4, v0
    s_and_b32 s63, s62, 1
    s_lshr_b32 s62, s62, 1
    s_lshl4_add_u32 s41, s63, s62
    s_lshl_b32 s41, s41, 5
    s_add_u32 s41, s41, s64
    s_lshl_b32 s41, s41, 8
    s_add_u32 s41, s41, s52
    s_lshl_b32 s41, s41, 7
    s_add_u32 s41, s41, 786432
    s_add_u32 s42, s41, 4096
    s_mov_b32 s6, 33554432
    s_mov_b32 s7, 0x20000
    v_xor_b32 v159, v156, v155
    v_lshlrev_b32 v159, 4, v159
    v_lshl_add_u32 v180, v155, 8, v159
    v_xor_b32 v181, 64, v180
    v_xor_b32 v182, 128, v180
    v_xor_b32 v183, 192, v180
    s_lshr_b32 s52, s52, 6
    s_mov_b32 s30, 268435456
    s_mov_b32 s31, 0x20000
    s_mov_b32 s34, 2304
    s_mov_b32 s35, 0x20000
    s_lshr_b32 s54, s2, 3
    v_lshlrev_b32 v2, 4, v0
    v_mov_b32 v176, -1
    v_mov_b32 v177, -1
    v_mov_b32 v178, -1
    v_mov_b32 v179, -1
    s_mul_i32 s55, s53, 187392
    s_lshl2_add_u32 s60, s54, s52
    s_waitcnt lgkmcnt(0)
    s_mov_b32 s67, 9445376
    buffer_load_dword v174, off, s[28:31], s67
    s_cmp_lg_u32 s52, 3
    s_cbranch_scc1 L_pro2
    v_lshrrev_b32 v160, 5, v0
    v_and_b32 v161, 31, v0
    v_mul_u32_u24 v35, 1152, v160
    v_lshl_add_u32 v36, v161, 2, v35
    v_lshl_add_u32 v162, v161, 3, v35
    v_lshl_add_u32 v35, v161, 4, v35
    buffer_load_dwordx4 v[136:139], v35, s[32:35], 0 offen
    buffer_load_dwordx4 v[140:143], v35, s[32:35], 0 offen offset:512
    buffer_load_dword v144, v36, s[32:35], 0 offen offset:1024
    s_mul_i32 s67, s64, 144
    buffer_load_dwordx2 v[132:133], v162, s[32:35], s67 offen
L_pro2:
    buffer_load_dwordx4 v158, s[12:15], s57 offen lds
    s_add_u32 m0, m0, 4096
    s_add_u32 s57, s57, 131072
    buffer_load_dwordx4 v158, s[12:15], s57 offen lds
    s_add_u32 m0, m0, 4096
    s_add_u32 s57, s57, 131072
    buffer_load_dwordx4 v158, s[12:15], s57 offen lds
    s_add_u32 m0, m0, 4096
    s_add_u32 s57, s57, 131072
    buffer_load_dwordx4 v158, s[12:15], s57 offen lds
    s_add_u32 m0, m0, 4096
    s_add_u32 s57, s57, 131072
    s_cmp_ge_u32 s52, 2
    s_cbranch_scc1 L_pro1
    buffer_load_dwordx4 v158, s[12:15], s57 offen lds
L_pro1:
    s_mul_i32 s67, s60, 944
    s_add_u32 s67, s67, s55
    s_mov_b32 exec_hi, 134217727
    buffer_store_dwordx4 v[176:179], v2, s[28:31], s67 offen
    s_mov_b32 exec_hi, -1
    s_lshl_b32 s66, s52, 13
    s_add_u32 m0, s66, 16384
    s_lshl1_add_u32 s66, s52, s54
    s_add_u32 s66, s66, s53
    s_and_b32 s66, s66, 7
    s_lshl_b32 s66, s66, 10
    s_or_b32 s41, s41, s66
    buffer_load_dwordx4 v180, s[4:7], s41 offen nt lds
    s_add_u32 m0, m0, 1024
    s_xor_b32 s42, s41, 1024
    buffer_load_dwordx4 v181, s[4:7], s42 offen nt lds
    s_add_u32 m0, m0, 1024
    s_xor_b32 s42, s41, 2048
    buffer_load_dwordx4 v182, s[4:7], s42 offen nt lds
    s_add_u32 m0, m0, 1024
    s_xor_b32 s42, s41, 3072
    buffer_load_dwordx4 v183, s[4:7], s42 offen nt lds
    s_add_u32 m0, m0, 1024
    s_xor_b32 s42, s41, 4096
    buffer_load_dwordx4 v180, s[4:7], s42 offen nt lds
    s_add_u32 m0, m0, 1024
    s_xor_b32 s42, s41, 5120
    buffer_load_dwordx4 v181, s[4:7], s42 offen nt lds
    s_add_u32 m0, m0, 1024
    s_xor_b32 s42, s41, 6144
    buffer_load_dwordx4 v182, s[4:7], s42 offen nt lds
    s_add_u32 m0, m0, 1024
    s_xor_b32 s42, s41, 7168
    buffer_load_dwordx4 v183, s[4:7], s42 offen nt lds
    s_mov_b32 s10, 33554432
    s_mov_b32 s11, 0x20000
    s_mov_b32 s18, 4718592
    s_mov_b32 s19, 0x20000
    s_mov_b32 s68, 0x00ff00ff
    s_mov_b32 s69, 0x00ff00ff
    v_lshlrev_b32 v10, 7, v0
    v_bfe_u32 v157, v0, 2, 1
    v_mul_u32_u24 v7, 1152, v157
    v_lshl_add_u32 v7, v155, 4, v7
    s_mul_i32 s66, s64, 144
    v_add_u32 v6, s66, v7
    v_mov_b32 v40, 0x3f803f80
    v_mov_b32 v41, 0x3f803f80
    v_mov_b32 v42, 0x3f803f80
    v_mov_b32 v43, 0x3f803f80
    v_mov_b32 v44, 0x3f803f80
    v_mov_b32 v45, 0x3f803f80
    v_mov_b32 v46, 0x3f803f80
    v_mov_b32 v47, 0x3f803f80
    v_mov_b32 v48, 0x3f803f80
    v_mov_b32 v49, 0x3f803f80
    v_mov_b32 v50, 0x3f803f80
    v_mov_b32 v51, 0x3f803f80
    s_lshl_b32 s66, s60, 9
    s_add_u32 s66, s66, 120832
    v_add_u32 v8, s66, v2
    s_load_dwordx2 s[20:21], s[0:1], 48
    s_load_dwordx2 s[24:25], s[0:1], 64
    s_load_dwordx2 s[36:37], s[0:1], 80
    s_load_dwordx2 s[44:45], s[0:1], 56
    s_load_dwordx2 s[48:49], s[0:1], 72
    v_and_b32 v160, 1, v0
    v_mul_u32_u24 v3, 0x5555, v160
    v_add_u32 v3, 0x8888, v3
    v_mov_b32 v39, 0x3f803f80
    s_lshl_b32 s65, s52, 6
    s_add_u32 s65, s65, 49152
    v_lshlrev_b32 v33, 10, v155
    v_lshl_add_u32 v33, v156, 2, v33
    v_add_u32 v33, s65, v33
    v_accvgpr_write_b32 a16, 0
    v_accvgpr_write_b32 a17, 0
    v_accvgpr_write_b32 a18, 0
    v_accvgpr_write_b32 a19, 0
    v_accvgpr_write_b32 a20, 0
    v_accvgpr_write_b32 a21, 0
    v_accvgpr_write_b32 a22, 0
    v_accvgpr_write_b32 a23, 0
    v_mov_b32 v64, 0
    v_mov_b32 v65, 0
    v_mov_b32 v66, 0
    v_mov_b32 v67, 0
    v_mov_b32 v68, 0
    v_mov_b32 v69, 0
    v_mov_b32 v70, 0
    v_mov_b32 v71, 0
    v_mul_u32_u24 v98, 144, v157
    v_lshl_add_u32 v98, v155, 4, v98
    s_lshl_b32 s65, s52, 11
    v_add_u32 v160, s65, v2
    ds_write_b128 v160, v[68:71] offset:1024
    ds_write_b128 v160, v[68:71] offset:2048
    s_mov_b32 s58, 0x400000
    s_mov_b32 s59, 0
    s_mov_b32 s56, s55
    s_cmp_lg_u32 s52, 3
    s_cbranch_scc1 L_c1
    s_waitcnt vmcnt(13)
    v_mov_b32 v152, 0
    v_mov_b32 v153, 0
    v_dot2c_f32_bf16 v152, v136, v39
    v_dot2c_f32_bf16 v153, v136, v136
    v_dot2c_f32_bf16 v152, v137, v39
    v_dot2c_f32_bf16 v153, v137, v137
    v_dot2c_f32_bf16 v152, v138, v39
    v_dot2c_f32_bf16 v153, v138, v138
    v_dot2c_f32_bf16 v152, v139, v39
    v_dot2c_f32_bf16 v153, v139, v139
    v_dot2c_f32_bf16 v152, v140, v39
    v_dot2c_f32_bf16 v153, v140, v140
    v_dot2c_f32_bf16 v152, v141, v39
    v_dot2c_f32_bf16 v153, v141, v141
    v_dot2c_f32_bf16 v152, v142, v39
    v_dot2c_f32_bf16 v153, v142, v142
    v_dot2c_f32_bf16 v152, v143, v39
    v_dot2c_f32_bf16 v153, v143, v143
    v_dot2c_f32_bf16 v152, v144, v39
    v_dot2c_f32_bf16 v153, v144, v144
    s_nop 2
    v_permlane16_swap_b32 v152, v153
    v_add_f32 v152, v152, v153
    s_nop 1
    v_add_f32_dpp v152, v152, v152 row_ror:8 row_mask:0xf bank_mask:0xf
    s_nop 1
    v_add_f32_dpp v152, v152, v152 row_ror:4 row_mask:0xf bank_mask:0xf
    s_nop 1
    v_add_f32_dpp v152, v152, v152 row_ror:2 row_mask:0xf bank_mask:0xf
    s_nop 1
    v_add_f32_dpp v152, v152, v152 row_ror:1 row_mask:0xf bank_mask:0xf
    v_mul_f32 v153, 0x3ae38e39, v152
    v_mul_f32 v152, 0x3ae38e39, v152
    s_nop 1
    v_permlane16_swap_b32 v152, v153
    v_fma_f32 v153, -v152, v152, v153
    v_max_f32 v153, 0, v153
    v_cvt_pk_bf16_f32 v153, v152, v153
    v_lshlrev_b32 v152, 16, v153
    v_and_b32 v153, 0xffff0000, v153
    v_add_f32 v153, 0x3727c5ac, v153
    v_cvt_pk_bf16_f32 v153, v153, v153
    v_and_b32 v153, 0xffff0000, v153
    v_sqrt_f32 v153, v153
    s_nop 0
    v_cvt_pk_bf16_f32 v153, v153, v153
    v_and_b32 v153, 0xffff0000, v153
    v_rcp_f32 v153, v153
    v_lshlrev_b32 v160, 16, v132
    v_and_b32 v161, 0xffff0000, v132
    v_sub_f32 v160, v160, v152
    v_sub_f32 v161, v161, v152
    v_cvt_pk_bf16_f32 v132, v160, v161
    v_lshlrev_b32 v160, 16, v132
    v_and_b32 v161, 0xffff0000, v132
    v_mul_f32 v160, v160, v153
    v_mul_f32 v161, v161, v153
    v_cvt_pk_bf16_f32 v132, v160, v161
    v_lshlrev_b32 v160, 16, v133
    v_and_b32 v161, 0xffff0000, v133
    v_sub_f32 v160, v160, v152
    v_sub_f32 v161, v161, v152
    v_cvt_pk_bf16_f32 v133, v160, v161
    v_lshlrev_b32 v160, 16, v133
    v_and_b32 v161, 0xffff0000, v133
    v_mul_f32 v160, v160, v153
    v_mul_f32 v161, v161, v153
    v_cvt_pk_bf16_f32 v133, v160, v161
    v_lshrrev_b32 v160, 5, v0
    v_mul_u32_u24 v160, 144, v160
    v_and_b32 v161, 31, v0
    v_lshl_add_u32 v160, v161, 3, v160
    s_mov_b32 exec_lo, 0x3ffff
    s_mov_b32 exec_hi, 0x3ffff
    ds_write_b64 v160, v[132:133] offset:640
    s_mov_b64 exec, -1
L_c1:
    s_lshl_b32 s66, s60, 9
    s_add_u32 s66, s66, s55
    s_add_u32 s66, s66, 120832
    s_add_u32 s57, s55, 186368
    s_mov_b64 exec, 15
    buffer_load_dword v172, v10, s[28:31], s66 offen sc1
    buffer_load_dword v172, v10, s[28:31], s57 offen sc1
    s_mov_b64 exec, -1
    buffer_load_dwordx4 a[56:59], v2, s[8:11], s41 offen nt
    s_xor_b32 s42, s41, 1024
    buffer_load_dwordx4 a[60:63], v2, s[8:11], s42 offen nt
    s_xor_b32 s42, s41, 2048
    buffer_load_dwordx4 a[64:67], v2, s[8:11], s42 offen nt
    s_xor_b32 s42, s41, 3072
    buffer_load_dwordx4 a[68:71], v2, s[8:11], s42 offen nt
    s_lshl_b32 s66, s60, 2
    s_add_u32 s66, s66, s57
    s_getreg_b32 s65, hwreg(HW_REG_XCC_ID)
    s_lshl_b32 s65, s65, 28
    s_or_b32 s65, s65, 1
    s_waitcnt vmcnt(14) lgkmcnt(0)
    s_barrier
    v_readfirstlane_b32 s43, v174
    s_nop 0
    s_add_u32 s43, s43, 0x0e377902
    s_and_b32 s43, s43, 0x0fffffff
    s_or_b32 s43, s43, s65
    v_mov_b32 v174, s43
    s_mov_b64 exec, 1
    buffer_store_dword v174, v2, s[28:31], s66 offen
    s_mov_b64 exec, -1
    v_and_b32 v173, 0xff, v174
    s_movk_i32 s66, 0xff
    s_mov_b32 exec_lo, 0x00330033
    s_mov_b32 exec_hi, 0x00330033
    ds_read_b128 v[40:43], v98 offset:640
    ds_read_b128 v[44:47], v98 offset:704
    s_mov_b64 exec, 0x33
    ds_read_b128 v[48:51], v98 offset:768
    s_mov_b64 exec, -1
    ds_read2st64_b32 a[0:1], v33 offset0:0 offset1:1
    ds_read2st64_b32 a[2:3], v33 offset0:2 offset1:3
    ds_read2st64_b32 a[4:5], v33 offset0:16 offset1:17
    ds_read2st64_b32 a[6:7], v33 offset0:18 offset1:19
    ds_read2st64_b32 a[8:9], v33 offset0:32 offset1:33
    ds_read2st64_b32 a[10:11], v33 offset0:34 offset1:35
    ds_read2st64_b32 a[12:13], v33 offset0:48 offset1:49
    ds_read2st64_b32 a[14:15], v33 offset0:50 offset1:51
    s_mov_b32 exec_hi, 0
    ds_read2st64_b32 a[16:17], v33 offset0:64 offset1:65
    ds_read2st64_b32 a[18:19], v33 offset0:66 offset1:67
    s_mov_b32 exec_hi, -1
    s_waitcnt lgkmcnt(0)
    v_smfmac_f32_16x16x64_bf16 v[64:67], v[40:43], a[0:7], v3
    v_smfmac_f32_16x16x64_bf16 v[64:67], v[44:47], a[8:15], v3
    v_smfmac_f32_16x16x64_bf16 v[64:67], v[48:51], a[16:23], v3
    s_nop 7
    v_bfi_b32 v64, s66, v173, v64
    v_bfi_b32 v65, s66, v173, v65
    v_bfi_b32 v66, s66, v173, v66
    v_bfi_b32 v67, s66, v173, v67
    s_mov_b32 exec_hi, 0
    buffer_store_dwordx4 v[64:67], v8, s[28:31], s55 offen
    s_mov_b32 exec_hi, -1
L_hQ:
    s_xor_b32 s42, s41, 4096
    buffer_load_dwordx4 a[72:75], v2, s[8:11], s42 offen nt
    s_xor_b32 s42, s41, 5120
    buffer_load_dwordx4 a[76:79], v2, s[8:11], s42 offen nt
    s_xor_b32 s42, s41, 6144
    buffer_load_dwordx4 a[80:83], v2, s[8:11], s42 offen nt
    s_xor_b32 s42, s41, 7168
    buffer_load_dwordx4 a[84:87], v2, s[8:11], s42 offen nt
    v_mul_u32_u24 v37, 1152, v155
    v_lshl_add_u32 v37, v156, 4, v37
    s_cmp_lt_u32 s54, 18
    s_cselect_b32 s3, 1, 0
    s_cmp_ge_u32 s54, 20
    s_cselect_b32 s66, 2, 0
    s_cmp_lt_u32 s52, 3
    s_cselect_b32 s66, s66, 0
    s_or_b32 s3, s3, s66
    s_sub_u32 s40, s54, 20
    s_mul_i32 s40, s40, 3
    s_add_u32 s40, s40, s52
    s_min_u32 s40, s40, 35
    s_lshl_b32 s65, s53, 4
    s_and_b32 s66, s54, 15
    s_add_u32 s61, s65, s66
    s_mul_i32 s61, s61, 36864
    s_lshl_b32 s66, s52, 8
    s_add_u32 s61, s61, s66
    s_mov_b32 s22, 5308416
    s_mov_b32 s23, 0x20000
    s_mov_b32 s26, 5308416
    s_mov_b32 s27, 0x20000
    s_mov_b32 s38, 2304
    s_mov_b32 s39, 0x20000
    s_mov_b32 s46, 9216
    s_mov_b32 s47, 0x20000
    s_mov_b32 s50, 1152
    s_mov_b32 s51, 0x20000
    s_mov_b32 s70, 0xffff0000
    s_mov_b32 s71, 0xffff0000
    v_lshlrev_b32 v1, 2, v0
    v_mov_b32 v52, 0x3f803f80
    v_mov_b32 v53, 0x3f803f80
    v_mov_b32 v54, 0x3f803f80
    v_mov_b32 v55, 0x3f803f80
    v_mov_b32 v56, 0x3f803f80
    v_mov_b32 v57, 0x3f803f80
    v_mov_b32 v58, 0x3f803f80
    v_mov_b32 v59, 0x3f803f80
    v_mov_b32 v60, 0x3f803f80
    v_mov_b32 v61, 0x3f803f80
    v_mov_b32 v62, 0x3f803f80
    v_mov_b32 v63, 0x3f803f80
    s_lshl_b32 s66, s52, 13
    s_add_u32 s66, s66, 16384
    v_lshl_add_u32 v100, v156, 8, v159
    v_add_u32 v100, s66, v100
    v_xor_b32 v101, 64, v100
    v_xor_b32 v102, 128, v100
    v_xor_b32 v103, 192, v100
    v_and_b32 v160, 1, v0
    v_mul_u32_u24 v4, 0xaaaa, v160
    v_add_u32 v4, 0x4444, v4
    v_and_b32 v161, 3, v0
    v_mul_u32_u24 v5, 0x5555, v161
    v_bfe_u32 v162, v0, 4, 1
    v_bfe_u32 v163, v0, 2, 2
    v_bfe_u32 v164, v0, 3, 1
    v_lshrrev_b32 v165, 5, v0
    v_and_b32 v168, 7, v0
    v_and_b32 v169, 31, v0
    s_lshr_b32 s65, s54, 4
    s_lshr_b32 s67, s54, 3
    s_lshl_b32 s65, s65, 1
    s_lshr_b32 s66, s52, 1
    s_add_u32 s65, s65, s66
    s_lshl_b32 s65, s65, 14
    s_and_b32 s66, s52, 1
    s_lshl_b32 s66, s66, 10
    s_add_u32 s65, s65, s66
    s_lshl_b32 s66, s63, 8
    s_add_u32 s65, s65, s66
    s_add_u32 s65, s65, 120832
    v_lshl_add_u32 v9, v165, 4, v162
    v_lshlrev_b32 v9, 9, v9
    v_lshl_add_u32 v9, v156, 4, v9
    v_add_u32 v9, s65, v9
    v_add_u32 v92, 4096, v9
    s_and_b32 s65, s52, 1
    s_lshl_b32 s65, s65, 8
    s_lshr_b32 s66, s52, 1
    s_lshl_b32 s66, s66, 7
    s_add_u32 s65, s65, s66
    v_bfe_u32 v166, v0, 3, 2
    v_bfe_u32 v167, v0, 1, 2
    v_lshlrev_b32 v11, 5, v166
    v_lshl_add_u32 v11, v160, 4, v11
    v_lshl_add_u32 v11, v167, 2, v11
    v_lshl_add_u32 v11, v165, 1, v11
    v_add_u32 v11, s65, v11
    v_lshlrev_b32 v12, 5, v155
    v_lshl_add_u32 v12, v164, 7, v12
    v_lshl_add_u32 v12, v160, 4, v12
    v_mul_u32_u24 v20, 640, v164
    v_lshl_add_u32 v20, v155, 5, v20
    v_lshl_add_u32 v20, v157, 4, v20
    s_mul_i32 s65, s52, 1280
    s_add_u32 s65, s65, 2560
    v_add_u32 v14, s65, v20
    v_add_u32 v20, 1024, v20
    v_bfe_u32 v166, v0, 1, 4
    v_mul_u32_u24 v13, 640, v165
    v_lshl_add_u32 v13, v166, 5, v13
    v_lshl_add_u32 v13, v160, 3, v13
    v_add_u32 v13, s65, v13
    v_lshrrev_b32 v38, 1, v0
    v_lshlrev_b32 v38, 4, v38
    v_lshl_add_u32 v38, v160, 2, v38
    v_add_u32 v38, 8192, v38
    s_lshl_b32 s65, s52, 9
    s_add_u32 s65, s65, 8192
    v_add_u32 v23, s65, v2
    s_lshl_b32 s65, s67, 9
    s_add_u32 s65, s65, 107008
    s_lshl_b32 s66, s64, 2
    s_add_u32 s66, s66, s52
    s_lshl_b32 s66, s66, 2
    s_add_u32 s66, s66, s65
    v_lshlrev_b32 v15, 8, v165
    v_lshl_add_u32 v15, v160, 7, v15
    v_add_u32 v15, s66, v15
    s_lshl_b32 s65, s63, 1
    s_lshr_b32 s66, s52, 1
    s_add_u32 s65, s65, s66
    s_lshl_b32 s65, s65, 9
    s_add_u32 s65, s65, 107008
    s_lshr_b32 s66, s64, 2
    s_lshl_b32 s66, s66, 8
    s_add_u32 s65, s65, s66
    v_lshrrev_b32 v167, 3, v0
    v_lshl_add_u32 v17, v167, 4, s65
    s_and_b32 s66, s52, 1
    s_lshl_b32 s66, s66, 3
    v_add_u32 v24, s66, v17
    s_lshr_b32 s65, s54, 4
    s_lshl_b32 s65, s65, 15
    s_lshl_b32 s66, s63, 11
    s_add_u32 s65, s65, s66
    s_lshl_b32 s66, s52, 9
    s_add_u32 s65, s65, s66
    s_lshl_b32 s66, s64, 6
    s_add_u32 s65, s65, s66
    v_lshlrev_b32 v166, 4, v161
    v_lshl_add_u32 v166, v162, 3, v166
    v_lshl_add_u32 v16, v165, 2, v163
    v_lshl_add_u32 v16, v16, 12, v166
    v_add_u32 v16, s65, v16
    s_and_b32 s65, s54, 15
    s_lshl_b32 s65, s65, 12
    s_lshl_b32 s66, s52, 10
    s_add_u32 s65, s65, s66
    v_lshl_add_u32 v18, v0, 3, s65
    s_lshr_b32 s65, s52, 1
    s_mul_i32 s65, s65, 640
    s_and_b32 s66, s52, 1
    s_lshl_b32 s66, s66, 1
    s_add_u32 s65, s65, s66
    s_add_u32 s65, s65, 1024
    v_mul_u32_u24 v19, 20, v164
    v_lshl_add_u32 v19, v168, 6, v19
    v_lshl_add_u32 v19, v165, 5, v19
    v_lshl_add_u32 v19, v162, 3, v19
    v_add_u32 v19, s65, v19
    s_mul_i32 s65, s52, 4608
    s_lshl_b32 s66, s54, 6
    s_add_u32 s65, s65, s66
    s_add_u32 s65, s65, 65536
    v_mul_u32_u24 v22, 18, v165
    v_add_u32 v22, v22, v163
    v_mul_u32_u24 v22, 1152, v22
    v_add3_u32 v22, v22, v166, s65
    v_subrev_u32 v21, 1024, v22
    v_lshlrev_b32 v94, 3, v0
    s_lshl_b32 s65, s63, 8
    s_add_u32 s65, s65, 118656
    v_lshl_add_u32 v26, v169, 3, s65
    v_mov_b32 v96, 0
    v_mov_b32 v97, 0
    v_mul_u32_u24 v35, 1152, v165
    v_lshl_add_u32 v36, v169, 2, v35
    v_lshl_add_u32 v35, v169, 4, v35
    s_mul_i32 s66, s52, 384
    v_add_u32 v7, s66, v7
    s_mul_i32 s66, s53, 18
    s_add_u32 s66, s66, s54
    s_lshl_b32 s67, s66, 6
    v_lshl_add_u32 v32, v169, 1, s67
    s_mul_i32 s66, s40, 1152
    s_add_u32 s66, s66, 65536
    v_lshl_add_u32 v25, v0, 3, s66
    s_sub_u32 s66, s60, 80
    s_and_b32 s66, s66, 63
    s_lshl_b32 s66, s66, 16
    s_lshl_b32 s67, s53, 10
    s_add_u32 s67, s67, s66
    v_lshl_add_u32 v28, v0, 3, s67
    s_lshl_b32 s67, s53, 7
    s_add_u32 s66, s66, s67
    v_lshl_add_u32 v27, v168, 4, s66
    v_lshrrev_b32 v167, 3, v0
    v_lshl_add_u32 v27, v167, 10, v27
    v_lshl_add_u32 v167, v156, 1, v165
    s_lshl_b32 s66, s40, 6
    v_lshl_add_u32 v34, v167, 1, s66
    v_add_u32 v29, 111104, v34
    s_and_b32 s67, s40, 7
    s_cmp_eq_u32 s67, s53
    s_cselect_b32 s67, 4, 0
    s_or_b32 s3, s3, s67
    s_cmp_ge_u32 s40, 18
    s_cselect_b32 s67, 1152, 0
    v_subrev_u32 v31, s67, v34
    s_cselect_b32 s67, 112, 0
    s_lshl_b32 s66, s40, 3
    s_add_u32 s66, s66, s67
    s_add_u32 s66, s66, 118144
    v_lshl_add_u32 v93, v162, 2, s66
    s_waitcnt lgkmcnt(0)
    s_waitcnt vmcnt(12)
    s_mov_b32 s42, 6291456
    s_cmp_lt_u32 s54, 16
    s_cbranch_scc1 L_g1n
    v_readfirstlane_b32 s66, v18
    v_readfirstlane_b32 s67, v17
    s_add_u32 s66, s66, s55
    s_add_u32 s67, s67, s55
    s_mov_b64 exec, 0xff
    s_nop 0
    buffer_load_dword v172, v10, s[28:31], s66 offen sc1
    s_mov_b64 exec, 3
    buffer_load_dword v172, v10, s[28:31], s67 offen sc1
    s_mov_b64 exec, -1
    buffer_load_ushort v30, v34, s[32:35], 0 offen
    buffer_load_ushort v31, v31, s[48:51], 0 offen
    buffer_load_dwordx4 a[88:91], v37, s[16:19], s61 offen
    s_add_u32 s61, s61, 4608
    buffer_load_dwordx4 a[92:95], v37, s[16:19], s61 offen
    s_add_u32 s61, s61, 4608
    buffer_load_dwordx4 a[96:99], v37, s[16:19], s61 offen
    s_add_u32 s61, s61, 4608
    buffer_load_dwordx4 a[100:103], v37, s[16:19], s61 offen
    s_add_u32 s61, s61, 4608
    buffer_load_dwordx4 a[104:107], v37, s[16:19], s61 offen
    s_add_u32 s61, s61, 4608
    buffer_load_dwordx4 a[108:111], v37, s[16:19], s61 offen
    s_add_u32 s61, s61, 4608
    buffer_load_dwordx4 a[112:115], v37, s[16:19], s61 offen
    s_add_u32 s61, s61, 4608
    buffer_load_dwordx4 a[116:119], v37, s[16:19], s61 offen
    s_add_u32 s61, s61, 4608
    s_cmp_lg_u32 s52, 3
    s_cbranch_scc1 L_wt_1
    s_mov_b64 exec, s[68:69]
    s_sub_u32 s61, s61, 4608
    buffer_load_dwordx4 a[228:231], v37, s[16:19], s61 offen offset:256
    s_sub_u32 s61, s61, 4608
    buffer_load_dwordx4 a[224:227], v37, s[16:19], s61 offen offset:256
    s_sub_u32 s61, s61, 4608
    buffer_load_dwordx4 a[220:223], v37, s[16:19], s61 offen offset:256
    s_sub_u32 s61, s61, 4608
    buffer_load_dwordx4 a[216:219], v37, s[16:19], s61 offen offset:256
    s_sub_u32 s61, s61, 4608
    buffer_load_dwordx4 a[212:215], v37, s[16:19], s61 offen offset:256
    s_sub_u32 s61, s61, 4608
    buffer_load_dwordx4 a[208:211], v37, s[16:19], s61 offen offset:256
    s_sub_u32 s61, s61, 4608
    buffer_load_dwordx4 a[204:207], v37, s[16:19], s61 offen offset:256
    s_sub_u32 s61, s61, 4608
    buffer_load_dwordx4 a[200:203], v37, s[16:19], s61 offen offset:256
    s_mov_b64 exec, -1
L_wt_1:
    s_branch L_g1o
L_g1n:
L_g1o:
    s_waitcnt vmcnt(8)
    ds_read_b128 a[24:27], v100 offset:0
    ds_read_b128 a[28:31], v101 offset:0
    ds_read_b128 a[32:35], v102 offset:0
    ds_read_b128 a[36:39], v103 offset:0
    ds_read_b128 a[40:43], v100 offset:4096
    ds_read_b128 a[44:47], v101 offset:4096
    ds_read_b128 a[48:51], v102 offset:4096
    ds_read_b128 a[52:55], v103 offset:4096
    s_waitcnt vmcnt(1)
L_g4:
    s_mov_b32 exec_hi, 0
    buffer_load_dwordx4 v[148:151], v2, s[28:31], s57 offen sc1
    s_mov_b32 exec_hi, -1
    buffer_load_dwordx4 v[196:199], v9, s[28:31], s56 offen offset:0 sc1
    buffer_load_dwordx4 v[200:203], v9, s[28:31], s56 offen offset:2048 sc1
    buffer_load_dwordx4 v[204:207], v92, s[28:31], s56 offen offset:0 sc1
    buffer_load_dwordx4 v[208:211], v92, s[28:31], s56 offen offset:2048 sc1
    s_waitcnt vmcnt(0)
    v_xor_b32 v175, s43, v148
    v_bitop3_b32 v175, v175, v149, s43 bitop3:0xf6
    v_bitop3_b32 v175, v175, v150, s43 bitop3:0xf6
    v_bitop3_b32 v175, v175, v151, s43 bitop3:0xf6
    v_cmp_ne_u32 vcc, 0, v175
    s_nop 0
    s_cmp_lg_u32 vcc_lo, 0
    s_cbranch_scc1 L_af2
    s_mov_b32 s59, 0
L_g2:
    v_xor_b32 v196, v173, v196
    v_xor_b32 v197, v173, v197
    v_xor_b32 v198, v173, v198
    v_xor_b32 v199, v173, v199
    v_xor_b32 v200, v173, v200
    v_xor_b32 v201, v173, v201
    v_xor_b32 v202, v173, v202
    v_xor_b32 v203, v173, v203
    v_xor_b32 v204, v173, v204
    v_xor_b32 v205, v173, v205
    v_xor_b32 v206, v173, v206
    v_xor_b32 v207, v173, v207
    v_xor_b32 v208, v173, v208
    v_xor_b32 v209, v173, v209
    v_xor_b32 v210, v173, v210
    v_xor_b32 v211, v173, v211
    v_or3_b32 v175, v196, v197, v198
    v_or3_b32 v175, v175, v199, v200
    v_or3_b32 v175, v175, v201, v202
    v_or3_b32 v175, v175, v203, v204
    v_or3_b32 v175, v175, v205, v206
    v_or3_b32 v175, v175, v207, v208
    v_or3_b32 v175, v175, v209, v210
    v_or_b32 v175, v175, v211
    v_and_b32 v175, 0xff, v175
    v_cmp_ne_u32 vcc, 0, v175
    s_cbranch_vccnz L_g5
L_g3:
    s_mov_b32 s60, 0
    v_mov_b32 v64, 0
    v_mov_b32 v65, 0
    v_mov_b32 v66, 0
    v_mov_b32 v67, 0
    v_mov_b32 v152, 0
    v_mov_b32 v153, 1.0
    v_add_f32 v154, v198, v202
    v_add_f32 v155, v199, v203
    v_add_f32 v156, v206, v210
    v_add_f32 v157, v207, v211
    v_add_f32 v154, v154, v156
    v_add_f32 v155, v155, v157
    s_nop 1
    v_permlane32_swap_b32 v154, v155
    v_add_f32 v33, v154, v155
    s_branch L_qfin
L_layer:
    v_mov_b32 v64, 0
    v_mov_b32 v65, 0
    v_mov_b32 v66, 0
    v_mov_b32 v67, 0
    v_mov_b32 v68, 0
    v_mov_b32 v69, 0
    v_mov_b32 v70, 0
    v_mov_b32 v71, 0
    s_bitcmp1_b32 s3, 1
    s_cbranch_scc1 L_q0
    s_add_u32 s67, s56, 118016
    s_mov_b64 exec, 1
.p2align 4
L_poll_2:
    buffer_load_dword v172, v2, s[28:31], s67 offen sc1
    s_sub_u32 s58, s58, 1
    s_cbranch_scc1 L_to_3
    s_waitcnt vmcnt(0)
    v_cmp_eq_u32 vcc, -1, v172
    s_cbranch_vccnz L_poll_2
L_ok_4:
    s_mov_b64 exec, -1
L_q0:
    s_mov_b32 exec_lo, 0x00330033
    s_mov_b32 exec_hi, 0x00330033
    buffer_load_dwordx4 v[40:43], v6, s[28:31], s57 offen offset:0 sc1
    buffer_load_dwordx4 v[44:47], v6, s[28:31], s57 offen offset:64 sc1
    s_mov_b64 exec, 0x33
    buffer_load_dwordx4 v[48:51], v6, s[28:31], s57 offen offset:128 sc1
    s_mov_b64 exec, -1
    s_mov_b32 exec_lo, 0x00330033
    s_mov_b32 exec_hi, 0x00330033
.p2align 4
L_poll_5:
    s_waitcnt vmcnt(0)
    v_smfmac_f32_16x16x64_bf16 v[64:67], v[40:43], a[0:7], v3
    buffer_load_dwordx4 v[40:43], v6, s[28:31], s57 offen offset:0 sc1
    v_smfmac_f32_16x16x64_bf16 v[64:67], v[44:47], a[8:15], v3
    buffer_load_dwordx4 v[44:47], v6, s[28:31], s57 offen offset:64 sc1
    v_smfmac_f32_16x16x64_bf16 v[64:67], v[48:51], a[16:23], v3
    s_mov_b64 exec, 0x33
    buffer_load_dwordx4 v[48:51], v6, s[28:31], s57 offen offset:128 sc1
    s_mov_b32 exec_lo, 0x00330033
    s_mov_b32 exec_hi, 0x00330033
    s_nop 3
    v_cmp_u_f32 vcc, v64, v65
    s_cbranch_vccnz L_retry_6
L_ok_7:
    s_mov_b64 exec, -1
    v_and_b32 v64, -2, v64
    v_and_b32 v65, -2, v65
    s_mov_b32 exec_hi, 0
    buffer_store_dwordx2 v[64:65], v8, s[28:31], s55 offen
    s_cmp_lg_u32 s59, 0
    s_cbranch_scc1 L_slow_9
L_back_10:
    s_mov_b32 exec_hi, -1
    v_mov_b32 v64, 0
    v_mov_b32 v65, 0
    v_mov_b32 v66, 0
    v_mov_b32 v67, 0
L_q1:
.p2align 4
L_poll_11:
    s_mov_b32 exec_lo, 0x3ffff
    s_mov_b32 exec_hi, 0x3ffff
    buffer_load_dwordx2 v[96:97], v26, s[28:31], s56 offen sc1
    s_mov_b64 exec, -1
    s_sub_u32 s58, s58, 1
    s_cbranch_scc1 L_to_12
    s_waitcnt vmcnt(0)
    v_max_u32 v175, v96, v97
    v_cmp_eq_u32 vcc, -1, v175
    s_cbranch_vccnz L_poll_11
L_ok_13:
    buffer_load_dwordx2 v[196:197], v9, s[28:31], s56 offen offset:0 sc1
    buffer_load_dwordx2 v[200:201], v9, s[28:31], s56 offen offset:2048 sc1
    buffer_load_dwordx2 v[204:205], v92, s[28:31], s56 offen offset:0 sc1
    buffer_load_dwordx2 v[208:209], v92, s[28:31], s56 offen offset:2048 sc1
    v_mov_b32 v152, v96
    v_mov_b32 v153, v97
    s_nop 1
    v_permlane16_swap_b32 v152, v153
    v_add_f32 v152, v152, v153
    s_nop 1
    v_add_f32_dpp v152, v152, v152 row_ror:8 row_mask:0xf bank_mask:0xf
    s_nop 1
    v_add_f32_dpp v152, v152, v152 row_ror:4 row_mask:0xf bank_mask:0xf
    s_nop 1
    v_add_f32_dpp v152, v152, v152 row_ror:2 row_mask:0xf bank_mask:0xf
    s_nop 1
    v_add_f32_dpp v152, v152, v152 row_ror:1 row_mask:0xf bank_mask:0xf
    v_mul_f32 v153, 0x3ae38e39, v152
    v_mul_f32 v152, 0x3ae38e39, v152
    s_nop 1
    v_permlane16_swap_b32 v152, v153
    v_fma_f32 v153, -v152, v152, v153
    v_max_f32 v153, 0, v153
    v_cvt_pk_bf16_f32 v153, v152, v153
    v_lshlrev_b32 v152, 16, v153
    v_and_b32 v153, 0xffff0000, v153
    v_add_f32 v153, 0x3727c5ac, v153
    v_cvt_pk_bf16_f32 v153, v153, v153
    v_and_b32 v153, 0xffff0000, v153
    v_sqrt_f32 v153, v153
    s_nop 0
    v_cvt_pk_bf16_f32 v153, v153, v153
    v_and_b32 v153, 0xffff0000, v153
    v_rcp_f32 v153, v153
    s_waitcnt vmcnt(0)
    v_or3_b32 v175, v196, v197, v200
    v_or3_b32 v175, v175, v201, v204
    v_or3_b32 v175, v175, v205, v208
    v_bitop3_b32 v175, v175, v209, 1 bitop3:0xa8
    v_cmp_ne_u32 vcc, 0, v175
    s_cbranch_vccnz L_more_17
L_ok_16:
L_qfin:
    v_add_f32 v154, v196, v200
    v_add_f32 v155, v197, v201
    v_add_f32 v156, v204, v208
    v_add_f32 v157, v205, v209
    v_add_f32 v154, v154, v156
    v_add_f32 v155, v155, v157
    s_nop 1
    v_permlane32_swap_b32 v154, v155
    v_add_f32 v154, v154, v155
    v_fma_f32 v154, -v152, v33, v154
    v_mul_f32 v154, v154, v153
    v_cvt_pk_bf16_f32 v154, v154, v154
    ds_write_b16 v11, v154 offset:0
    s_mov_b32 vcc_lo, 0xaaaaaaaa
    s_mov_b32 vcc_hi, 0xaaaaaaaa
    v_mov_b32 v72, 0
    v_mov_b32 v73, 0
    v_mov_b32 v74, 0
    v_mov_b32 v75, 0
    s_waitcnt lgkmcnt(0)
    s_barrier
    ds_read_b128 v[76:79], v12 offset:0
    ds_read_b128 v[80:83], v12 offset:256
    s_waitcnt lgkmcnt(1)
    v_smfmac_f32_16x16x64_bf16 v[64:67], v[76:79], a[24:31], v4
    v_smfmac_f32_16x16x64_bf16 v[68:71], v[76:79], a[40:47], v4
    s_waitcnt lgkmcnt(0)
    v_smfmac_f32_16x16x64_bf16 v[64:67], v[80:83], a[32:39], v4
    v_smfmac_f32_16x16x64_bf16 v[68:71], v[80:83], a[48:55], v4
    s_nop 6
    v_add_f32 v152, v64, v65
    v_add_f32 v156, v68, v69
    v_cndmask_b32 v152, v152, v156, s[70:71]
    v_cvt_pk_bf16_f32 v152, v152, v152
    v_and_b32 v152, 0xffff0000, v152
    v_mul_f32 v152, 0x3db504f3, v152
    v_cvt_pk_bf16_f32 v152, v152, v152
    v_and_b32 v152, 0xffff0000, v152
    v_mul_f32 v152, 0x3fb8aa3b, v152
    v_mov_b32 v64, 0
    v_mov_b32 v65, 0
    v_max_f32_dpp v153, v152, v152 row_ror:8 row_mask:0xf bank_mask:0xf
    v_mov_b32 v66, 0
    v_mov_b32 v67, 0
    v_max_f32_dpp v153, v153, v153 row_ror:4 row_mask:0xf bank_mask:0xf
    v_mov_b32 v68, 0
    v_mov_b32 v69, 0
    v_max_f32_dpp v153, v153, v153 row_ror:2 row_mask:0xf bank_mask:0xf
    v_mov_b32 v70, 0
    v_mov_b32 v71, 0
    v_max_f32_dpp v156, v153, v153 row_ror:1 row_mask:0xf bank_mask:0xf
    v_max_f32_dpp v153, v153, v153 row_ror:1 row_mask:0xf bank_mask:0xf
    s_nop 1
    v_permlane16_swap_b32 v153, v156
    v_max_f32 v153, v153, v156
    v_sub_f32 v154, v152, v153
    v_exp_f32 v154, v154
    s_nop 0
    v_cvt_pk_bf16_f32 v156, v154, 0
    ds_write2_b32 v13, v156, v156 offset1:5
    ds_read_b128 v[76:79], v14 offset:0
    ds_read_b128 v[80:83], v14 offset:128
    ds_read_b128 v[84:87], v14 offset:256
    ds_read_b128 v[88:91], v14 offset:384
    v_add_f32_dpp v155, v154, v154 row_ror:8 row_mask:0xf bank_mask:0xf
    s_nop 1
    v_add_f32_dpp v155, v155, v155 row_ror:4 row_mask:0xf bank_mask:0xf
    s_nop 1
    v_add_f32_dpp v155, v155, v155 row_ror:2 row_mask:0xf bank_mask:0xf
    s_nop 1
    v_add_f32_dpp v155, v155, v155 row_ror:1 row_mask:0xf bank_mask:0xf
    v_mov_b32 v152, v155
    s_nop 1
    v_permlane16_swap_b32 v155, v152
    v_add_f32 v155, v155, v152
    v_cndmask_b32 v152, v153, v155, vcc
    s_mov_b32 exec_lo, 3
    s_mov_b32 exec_hi, 3
    buffer_store_dword v152, v15, s[28:31], s55 offen
    s_cmp_lg_u32 s59, 0
    s_cbranch_scc1 L_slow_18
L_back_19:
    s_mov_b64 exec, -1
    s_waitcnt lgkmcnt(3)
    v_smfmac_f32_16x16x64_bf16 v[72:75], v[76:79], a[56:63], v5
    s_waitcnt lgkmcnt(2)
    v_smfmac_f32_16x16x64_bf16 v[72:75], v[80:83], a[64:71], v5
    s_waitcnt lgkmcnt(1)
    v_smfmac_f32_16x16x64_bf16 v[72:75], v[84:87], a[72:79], v5
    s_waitcnt lgkmcnt(0)
    v_smfmac_f32_16x16x64_bf16 v[72:75], v[88:91], a[80:87], v5
    s_nop 7
    v_cvt_pk_bf16_f32 v72, v72, v73
    v_cvt_pk_bf16_f32 v73, v74, v75
    buffer_store_dwordx2 v[72:73], v16, s[28:31], s55 offen
    s_cmp_lg_u32 s59, 0
    s_cbranch_scc1 L_slow_20
L_back_21:
    s_cmp_lt_u32 s54, 16
    s_cbranch_scc1 L_mlp
    v_add_u32 v163, 4608, v21
    buffer_load_dwordx4 v[104:107], v17, s[28:31], s56 offen sc1
    buffer_load_dwordx4 v[108:111], v17, s[28:31], s56 offen offset:128 sc1
    buffer_load_dwordx2 v[112:113], v24, s[28:31], s56 offen sc1
    s_sleep 2
.p2align 4
L_poll_22:
    buffer_load_dwordx4 v[104:107], v17, s[28:31], s56 offen sc1
    buffer_load_dwordx4 v[108:111], v17, s[28:31], s56 offen offset:128 sc1
    buffer_load_dwordx2 v[112:113], v24, s[28:31], s56 offen sc1
    s_sub_u32 s58, s58, 1
    s_cbranch_scc1 L_to_23
    s_waitcnt vmcnt(3)
    v_max3_u32 v175, v104, v105, v106
    v_max3_u32 v175, v175, v107, v108
    v_max3_u32 v175, v175, v109, v110
    v_max3_u32 v175, v175, v111, v112
    v_max_u32 v175, v175, v113
    v_cmp_eq_u32 vcc, -1, v175
    s_cbranch_vccnz L_poll_22
L_ok_24:
    buffer_load_dwordx2 v[188:189], v18, s[28:31], s56 offen offset:0 sc1
    buffer_load_dwordx2 v[190:191], v18, s[28:31], s56 offen offset:512 sc1
    v_max3_f32 v153, v104, v105, v106
    v_max_f32 v153, v153, v107
    s_nop 1
    v_max_f32_dpp v156, v153, v153 row_ror:8 row_mask:0xf bank_mask:0xf
    v_max_f32_dpp v153, v153, v153 row_ror:8 row_mask:0xf bank_mask:0xf
    s_nop 1
    v_permlane16_swap_b32 v153, v156
    v_max_f32 v152, v153, v156
    v_max_f32 v153, v153, v156
    s_nop 1
    v_permlane32_swap_b32 v153, v152
    v_max_f32 v153, v153, v152
    v_sub_f32 v157, v104, v153
    v_sub_f32 v158, v105, v153
    v_sub_f32 v159, v106, v153
    v_sub_f32 v160, v107, v153
    v_sub_f32 v161, v112, v153
    v_sub_f32 v162, v113, v153
    v_exp_f32 v157, v157
    v_exp_f32 v158, v158
    v_exp_f32 v159, v159
    v_exp_f32 v160, v160
    v_exp_f32 v161, v161
    v_exp_f32 v162, v162
    v_mul_f32 v155, v157, v108
    v_fmac_f32 v155, v158, v109
    v_fmac_f32 v155, v159, v110
    v_fmac_f32 v155, v160, v111
    s_nop 1
    v_add_f32_dpp v156, v155, v155 row_ror:8 row_mask:0xf bank_mask:0xf
    v_add_f32_dpp v155, v155, v155 row_ror:8 row_mask:0xf bank_mask:0xf
    s_nop 1
    v_permlane16_swap_b32 v155, v156
    v_add_f32 v152, v155, v156
    v_add_f32 v155, v155, v156
L_exw:
    s_waitcnt vmcnt(0)
    v_max3_u32 v175, v188, v189, v190
    v_max_u32 v175, v175, v191
    v_cmp_eq_u32 vcc, -1, v175
    s_cbranch_vccnz L_more_28
L_ok_27:
    v_permlane32_swap_b32 v155, v152
    v_lshlrev_b32 v164, 16, v188
    v_and_b32 v165, 0xffff0000, v188
    v_lshlrev_b32 v166, 16, v189
    v_and_b32 v167, 0xffff0000, v189
    v_lshlrev_b32 v192, 16, v190
    v_and_b32 v193, 0xffff0000, v190
    v_lshlrev_b32 v194, 16, v191
    v_and_b32 v195, 0xffff0000, v191
    v_pk_mul_f32 v[164:165], v[164:165], v[160:161] op_sel:[0,1] op_sel_hi:[1,1]
    v_pk_mul_f32 v[166:167], v[166:167], v[160:161] op_sel:[0,1] op_sel_hi:[1,1]
    v_pk_fma_f32 v[164:165], v[192:193], v[162:163], v[164:165] op_sel_hi:[1,0,1]
    v_pk_fma_f32 v[166:167], v[194:195], v[162:163], v[166:167] op_sel_hi:[1,0,1]
    v_add_f32 v155, v155, v152
    v_mov_b32 v159, v163
    v_permlane32_swap_b32 v164, v166
    v_permlane32_swap_b32 v165, v167
    v_add_f32 v164, v164, v166
    v_add_f32 v165, v165, v167
    v_rcp_f32 v155, v155
    s_nop 0
    v_permlane16_swap_b32 v164, v165
    v_add_f32 v164, v164, v165
    s_nop 1
    v_add_f32_dpp v164, v164, v164 row_ror:8 row_mask:0xf bank_mask:0xf
    v_mul_f32 v164, v164, v155
    v_cvt_pk_bf16_f32 v156, v164, v164
    ds_write_b16 v19, v156
    s_cmp_lg_u32 s60, 0
    s_cbranch_scc1 L_o3
    buffer_store_dwordx2 v[176:177], v18, s[28:31], s55 offen offset:0
    buffer_store_dwordx2 v[176:177], v18, s[28:31], s55 offen offset:512
    s_cmp_lg_u32 s59, 0
    s_cbranch_scc1 L_slow_29
L_back_30:
L_o3:
    s_waitcnt lgkmcnt(0)
    s_barrier
    ds_read_b128 v[76:79], v20 offset:0
    ds_read_b128 v[80:83], v20 offset:128
    ds_read_b128 v[84:87], v20 offset:256
    ds_read_b128 v[88:91], v20 offset:384
    s_waitcnt lgkmcnt(3)
    v_smfmac_f32_16x16x64_bf16 v[64:67], v[76:79], a[88:95], v5
    s_waitcnt lgkmcnt(2)
    v_smfmac_f32_16x16x64_bf16 v[64:67], v[80:83], a[96:103], v5
    s_waitcnt lgkmcnt(1)
    v_smfmac_f32_16x16x64_bf16 v[64:67], v[84:87], a[104:111], v5
    s_waitcnt lgkmcnt(0)
    v_smfmac_f32_16x16x64_bf16 v[64:67], v[88:91], a[112:119], v5
    s_cmp_lg_u32 s52, 3
    s_cbranch_scc1 L_t_31
    v_smfmac_f32_16x16x64_bf16 v[68:71], v[76:79], a[200:207], v5
    v_smfmac_f32_16x16x64_bf16 v[68:71], v[80:83], a[208:215], v5
    v_smfmac_f32_16x16x64_bf16 v[68:71], v[84:87], a[216:223], v5
    v_smfmac_f32_16x16x64_bf16 v[68:71], v[88:91], a[224:231], v5
L_t_31:
    s_waitcnt vmcnt(0)
    s_nop 4
    v_cvt_pk_bf16_f32 v64, v64, v65
    v_cvt_pk_bf16_f32 v65, v66, v67
    buffer_store_dwordx2 v[64:65], v21, s[28:31], s55 offen
    s_cmp_lg_u32 s59, 0
    s_cbranch_scc1 L_slow_33
L_back_34:
    s_cmp_lg_u32 s52, 3
    s_cbranch_scc1 L_t_32
    v_cvt_pk_bf16_f32 v68, v68, v69
    v_cvt_pk_bf16_f32 v69, v70, v71
    s_mov_b64 exec, s[68:69]
    buffer_store_dwordx2 v[68:69], v159, s[28:31], s55 offen
    s_cmp_lg_u32 s59, 0
    s_cbranch_scc1 L_slow_35
L_back_36:
    s_mov_b64 exec, -1
L_t_32:
    s_bitcmp1_b32 s3, 0
    s_cbranch_scc1 L_mlp
    s_bitcmp1_b32 s3, 1
    s_cbranch_scc0 L_probe
    s_cmp_lg_u32 s60, 0
    s_cbranch_scc1 L_red
    v_lshlrev_b32 v30, 16, v30
    v_lshlrev_b32 v31, 16, v31
    v_mov_b32 v126, 0
    v_mov_b32 v127, 0
    v_mov_b32 v128, 0x3f80
    v_mov_b32 v129, 0x3f80
    v_mov_b32 v130, 0x3f80
    v_mov_b32 v131, 0x3f80
L_red:
    s_movk_i32 s66, 0xff
    s_add_u32 s65, s42, 8192
    v_mov_b32 v164, 0
    v_mov_b32 v165, 0
    v_mov_b32 v166, 0
    v_mov_b32 v167, 0
    v_mov_b32 v124, 0
    v_mov_b32 v125, 0
    buffer_load_dwordx2 v[120:121], v25, s[28:31], s56 offen offset:0 sc1
    buffer_load_dwordx2 v[122:123], v25, s[28:31], s56 offen offset:512 sc1
    s_sleep 2
.p2align 4
L_poll_37:
    buffer_load_dwordx2 v[120:121], v25, s[28:31], s56 offen offset:0 sc1
    buffer_load_dwordx2 v[122:123], v25, s[28:31], s56 offen offset:512 sc1
    s_sub_u32 s58, s58, 1
    s_cbranch_scc1 L_to_38
    s_waitcnt vmcnt(2)
    v_max3_u32 v175, v120, v121, v122
    v_max_u32 v175, v175, v123
    v_cmp_eq_u32 vcc, -1, v175
    s_cbranch_vccnz L_poll_37
L_ok_39:
    v_smfmac_f32_16x16x64_bf16 v[164:167], v[128:131], v[120:127], v5
    s_nop 7
    v_add_f32_dpp v164, v164, v164 row_ror:8 row_mask:0xf bank_mask:0xf
    v_add_f32_dpp v165, v165, v165 row_ror:8 row_mask:0xf bank_mask:0xf
    v_add_f32_dpp v166, v166, v166 row_ror:8 row_mask:0xf bank_mask:0xf
    v_add_f32_dpp v167, v167, v167 row_ror:8 row_mask:0xf bank_mask:0xf
    v_bfi_b32 v164, s66, v173, v164
    v_bfi_b32 v165, s66, v173, v165
    v_bfi_b32 v166, s66, v173, v166
    v_bfi_b32 v167, s66, v173, v167
    buffer_store_dwordx4 v[164:167], v27, s[28:31], s42 offen sc1
    buffer_store_dwordx4 v[164:167], v27, s[28:31], s65 offen sc1
    buffer_store_dwordx2 v[176:177], v25, s[28:31], s55 offen offset:0
    buffer_store_dwordx2 v[176:177], v25, s[28:31], s55 offen offset:512
    s_cmp_lg_u32 s59, 0
    s_cbranch_scc1 L_slow_40
L_back_41:
    s_cmp_lg_u32 s40, 0
    s_cbranch_scc1 L_an_42
    s_cmp_eq_u32 s60, 0
    s_cbranch_scc1 L_an_42
    v_mov_b32 v156, 118020
    s_mov_b64 exec, 1
    buffer_store_dword v2, v156, s[28:31], s55 offen
    s_cmp_lg_u32 s59, 0
    s_cbranch_scc1 L_slow_43
L_back_44:
    s_mov_b64 exec, -1
L_an_42:
    v_mov_b32 v156, 0
    ds_read_b32 v156, v156 offset:8176
    s_sleep 11
    s_waitcnt lgkmcnt(0)
    v_or_b32 v28, v28, v156
.p2align 4
L_poll_45:
    buffer_load_dwordx2 v[132:133], v28, s[28:31], s42 offen sc1
    buffer_load_dwordx2 v[134:135], v28, s[28:31], s42 offen offset:512 sc1
    s_sub_u32 s58, s58, 1
    s_cbranch_scc1 L_to_46
    s_waitcnt vmcnt(0)
    v_xor_b32 v164, v173, v132
    v_xor_b32 v165, v173, v133
    v_xor_b32 v166, v173, v134
    v_xor_b32 v167, v173, v135
    v_or3_b32 v175, v164, v165, v166
    v_bitop3_b32 v175, v175, v167, s66 bitop3:0xa8
    v_cmp_ne_u32 vcc, 0, v175
    s_cbranch_vccnz L_poll_45
L_ok_47:
    v_add_f32 v164, v164, v166
    v_add_f32 v165, v165, v167
    s_nop 1
    v_permlane32_swap_b32 v164, v165
    v_add_f32 v156, v164, v165
    v_add_f32 v164, v164, v165
    s_nop 1
    v_permlane16_swap_b32 v164, v156
    v_add_f32 v164, v164, v156
    v_cvt_pk_bf16_f32 v164, v164, v164
    v_and_b32 v164, 0xffff0000, v164
    v_add_f32 v156, v164, v30
    v_add_f32 v165, v164, v30
    v_add_f32 v164, v164, v30
    s_mov_b64 exec, -1
    v_permlane32_swap_b32 v156, v165
    v_cvt_pk_bf16_f32 v156, v156, v165
    s_mov_b64 exec, 0xffff
    buffer_store_dword v156, v29, s[28:31], s55 offen
    s_cmp_lg_u32 s59, 0
    s_cbranch_scc1 L_slow_48
L_back_49:
    s_mov_b64 exec, -1
    v_cvt_pk_bf16_f32 v30, v164, v164
    v_and_b32 v30, 0xffff0000, v30
    v_add_u32 v93, 512, v93
    v_add_u32 v29, 2304, v29
    s_add_u32 s42, s42, 16384
    s_movk_i32 s66, 0xff
    s_add_u32 s65, s42, 8192
    v_mov_b32 v164, 0
    v_mov_b32 v165, 0
    v_mov_b32 v166, 0
    v_mov_b32 v167, 0
    buffer_load_dwordx2 v[120:121], v25, s[28:31], s56 offen offset:0 sc1
    buffer_load_dwordx2 v[122:123], v25, s[28:31], s56 offen offset:512 sc1
    s_mov_b64 exec, 0xffff
    buffer_load_dwordx2 v[124:125], v25, s[28:31], s56 offen offset:1024 sc1
    s_mov_b64 exec, -1
    s_sleep 2
.p2align 4
L_poll_50:
    buffer_load_dwordx2 v[120:121], v25, s[28:31], s56 offen offset:0 sc1
    buffer_load_dwordx2 v[122:123], v25, s[28:31], s56 offen offset:512 sc1
    s_mov_b64 exec, 0xffff
    buffer_load_dwordx2 v[124:125], v25, s[28:31], s56 offen offset:1024 sc1
    s_mov_b64 exec, -1
    s_sub_u32 s58, s58, 1
    s_cbranch_scc1 L_to_51
    s_waitcnt vmcnt(3)
    v_max3_u32 v175, v120, v121, v122
    v_max3_u32 v175, v175, v123, v124
    v_max_u32 v175, v175, v125
    v_cmp_eq_u32 vcc, -1, v175
    s_cbranch_vccnz L_poll_50
L_ok_52:
    v_smfmac_f32_16x16x64_bf16 v[164:167], v[128:131], v[120:127], v5
    s_nop 7
    v_add_f32_dpp v164, v164, v164 row_ror:8 row_mask:0xf bank_mask:0xf
    v_add_f32_dpp v165, v165, v165 row_ror:8 row_mask:0xf bank_mask:0xf
    v_add_f32_dpp v166, v166, v166 row_ror:8 row_mask:0xf bank_mask:0xf
    v_add_f32_dpp v167, v167, v167 row_ror:8 row_mask:0xf bank_mask:0xf
    v_bfi_b32 v164, s66, v173, v164
    v_bfi_b32 v165, s66, v173, v165
    v_bfi_b32 v166, s66, v173, v166
    v_bfi_b32 v167, s66, v173, v167
    buffer_store_dwordx4 v[164:167], v27, s[28:31], s42 offen sc1
    buffer_store_dwordx4 v[164:167], v27, s[28:31], s65 offen sc1
    s_lshl_b32 s62, s60, 2
    s_andn2_b32 s62, s62, s3
    s_cbranch_scc1 L_fin
    buffer_store_dwordx2 v[176:177], v25, s[28:31], s55 offen offset:0
    buffer_store_dwordx2 v[176:177], v25, s[28:31], s55 offen offset:512
    s_mov_b64 exec, 0xffff
    buffer_store_dwordx2 v[176:177], v25, s[28:31], s55 offen offset:1024
    s_mov_b64 exec, -1
    s_cmp_lg_u32 s59, 0
    s_cbranch_scc1 L_slow_53
L_back_54:
    s_cmp_lg_u32 s40, 0
    s_cbranch_scc1 L_an_55
    v_mov_b32 v156, 118016
    s_mov_b64 exec, 1
    buffer_store_dword v2, v156, s[28:31], s55 offen
    s_cmp_lg_u32 s59, 0
    s_cbranch_scc1 L_slow_56
L_back_57:
    s_mov_b64 exec, -1
L_an_55:
    v_mov_b32 v156, 0
    ds_read_b32 v156, v156 offset:8176
    s_sleep 11
    s_waitcnt lgkmcnt(0)
    v_or_b32 v28, v28, v156
.p2align 4
L_poll_58:
    buffer_load_dwordx2 v[132:133], v28, s[28:31], s42 offen sc1
    buffer_load_dwordx2 v[134:135], v28, s[28:31], s42 offen offset:512 sc1
    s_sub_u32 s58, s58, 1
    s_cbranch_scc1 L_to_59
    s_waitcnt vmcnt(0)
    v_xor_b32 v164, v173, v132
    v_xor_b32 v165, v173, v133
    v_xor_b32 v166, v173, v134
    v_xor_b32 v167, v173, v135
    v_or3_b32 v175, v164, v165, v166
    v_bitop3_b32 v175, v175, v167, s66 bitop3:0xa8
    v_cmp_ne_u32 vcc, 0, v175
    s_cbranch_vccnz L_poll_58
L_ok_60:
    v_add_f32 v164, v164, v166
    v_add_f32 v165, v165, v167
    s_nop 1
    v_permlane32_swap_b32 v164, v165
    v_add_f32 v156, v164, v165
    v_add_f32 v164, v164, v165
    s_nop 1
    v_permlane16_swap_b32 v164, v156
    v_add_f32 v164, v164, v156
    v_cvt_pk_bf16_f32 v164, v164, v164
    v_and_b32 v164, 0xffff0000, v164
    v_add_f32 v164, v164, v31
    v_cvt_pk_bf16_f32 v164, v164, v164
    v_and_b32 v164, 0xffff0000, v164
    v_add_f32 v156, v164, v30
    v_add_f32 v165, v164, v30
    v_add_f32 v164, v164, v30
    s_mov_b64 exec, -1
    v_permlane32_swap_b32 v156, v165
    v_cvt_pk_bf16_f32 v156, v156, v165
    s_mov_b64 exec, 0xffff
    s_cmp_lg_u32 s60, 0
    s_cbranch_scc1 L_out
    buffer_store_dword v156, v29, s[28:31], s55 offen
    s_cmp_lg_u32 s59, 0
    s_cbranch_scc1 L_slow_61
L_back_62:
    s_mov_b64 exec, -1
    v_cvt_pk_bf16_f32 v30, v164, v164
    v_and_b32 v30, 0xffff0000, v30
    v_mul_f32 v156, v30, v30
    v_cndmask_b32 v156, v30, v156, s[70:71]
    s_nop 1
    v_add_f32_dpp v156, v156, v156 row_ror:8 row_mask:0xf bank_mask:0xf
    s_nop 1
    v_add_f32_dpp v156, v156, v156 row_ror:4 row_mask:0xf bank_mask:0xf
    s_nop 1
    v_add_f32_dpp v156, v156, v156 row_ror:2 row_mask:0xf bank_mask:0xf
    s_nop 1
    v_add_f32_dpp v164, v156, v156 row_ror:1 row_mask:0xf bank_mask:0xf
    v_add_f32_dpp v156, v156, v156 row_ror:1 row_mask:0xf bank_mask:0xf
    s_nop 1
    v_permlane32_swap_b32 v156, v164
    v_add_f32 v156, v156, v164
    s_mov_b64 exec, 0x10001
    buffer_store_dword v156, v93, s[28:31], s55 offen
    s_cmp_lg_u32 s59, 0
    s_cbranch_scc1 L_slow_63
L_back_64:
    s_mov_b64 exec, -1
    v_add_u32 v93, 512, v93
    v_add_u32 v29, 2304, v29
    s_add_u32 s42, s42, 16384
    s_branch L_next
L_mlp:
    s_cmp_lg_u32 s60, 0
    s_cbranch_scc1 L_m1
    s_mul_i32 s62, s53, 18
    s_add_u32 s62, s62, s54
    s_lshl_b32 s64, s62, 6
    buffer_load_ushort v32, v32, s[44:47], 0 offen
    s_cmp_ge_u32 s54, 16
    s_cbranch_scc1 L_m0b
    s_lshl_b32 s63, s54, 2
    s_add_u32 s63, s63, s52
    s_mul_i32 s65, s63, 896
    s_add_u32 s65, s65, s55
    s_add_u32 s65, s65, 65536
    s_mov_b64 exec, 0x7f
    buffer_load_dword v172, v10, s[28:31], s65 offen sc1
    s_mov_b64 exec, -1
L_m0b:
    s_cmp_ge_u32 s54, 16
    s_cbranch_scc1 L_nt_65
    s_lshl_b32 s63, s54, 2
    s_add_u32 s63, s63, s52
    s_mul_i32 s66, s53, 576
    s_add_u32 s66, s66, s63
    s_add_u32 s66, s66, 512
    s_mul_i32 s66, s66, 1152
    s_mul_i32 s63, s63, 82944
    s_mul_i32 s65, s53, 1152
    s_add_u32 s63, s63, s65
    s_add_u32 s65, s63, 46080
    v_mul_u32_u24 v156, 57, v0
    v_lshrrev_b32 v156, 9, v156
    v_mul_u32_u24 v156, 8064, v156
    v_add_u32 v156, v156, v10
    s_mov_b32 exec_hi, 0x1fff
    buffer_load_dword v172, v156, s[20:23], s63 offen
    s_mov_b32 exec_hi, 15
    buffer_load_dword v172, v156, s[20:23], s65 offen
    s_mov_b64 exec, 0x1ff
    buffer_load_dword v172, v10, s[24:27], s66 offen
    s_mov_b64 exec, -1
L_nt_65:
    s_mul_i32 s62, s53, 18
    s_add_u32 s62, s62, s54
    s_mul_i32 s62, s62, 36864
    s_lshl_b32 s63, s52, 8
    s_add_u32 s63, s63, s62
    buffer_load_dwordx4 a[168:171], v37, s[24:27], s63 offen nt
    s_add_u32 s63, s63, 4608
    buffer_load_dwordx4 a[172:175], v37, s[24:27], s63 offen nt
    s_add_u32 s63, s63, 4608
    buffer_load_dwordx4 a[176:179], v37, s[24:27], s63 offen nt
    s_add_u32 s63, s63, 4608
    buffer_load_dwordx4 a[180:183], v37, s[24:27], s63 offen nt
    s_add_u32 s63, s63, 4608
    buffer_load_dwordx4 a[184:187], v37, s[24:27], s63 offen nt
    s_add_u32 s63, s63, 4608
    buffer_load_dwordx4 a[188:191], v37, s[24:27], s63 offen nt
    s_add_u32 s63, s63, 4608
    buffer_load_dwordx4 a[192:195], v37, s[24:27], s63 offen nt
    s_add_u32 s63, s63, 4608
    buffer_load_dwordx4 a[196:199], v37, s[24:27], s63 offen nt
    s_cmp_lg_u32 s52, 3
    s_cbranch_scc1 L_w2_66
    s_mov_b64 exec, s[68:69]
    buffer_load_dwordx4 a[120:123], v37, s[24:27], s62 offen offset:1024 nt
    s_add_u32 s62, s62, 4608
    buffer_load_dwordx4 a[124:127], v37, s[24:27], s62 offen offset:1024 nt
    s_add_u32 s62, s62, 4608
    buffer_load_dwordx4 a[128:131], v37, s[24:27], s62 offen offset:1024 nt
    s_add_u32 s62, s62, 4608
    buffer_load_dwordx4 a[132:135], v37, s[24:27], s62 offen offset:1024 nt
    s_add_u32 s62, s62, 4608
    buffer_load_dwordx4 a[136:139], v37, s[24:27], s62 offen offset:1024 nt
    s_add_u32 s62, s62, 4608
    buffer_load_dwordx4 a[140:143], v37, s[24:27], s62 offen offset:1024 nt
    s_add_u32 s62, s62, 4608
    buffer_load_dwordx4 a[144:147], v37, s[24:27], s62 offen offset:1024 nt
    s_add_u32 s62, s62, 4608
    buffer_load_dwordx4 a[148:151], v37, s[24:27], s62 offen offset:1024 nt
    s_mov_b64 exec, -1
L_w2_66:
    s_waitcnt vmcnt(6)
    s_cmp_eq_u32 s52, 3
    s_cbranch_scc1 L_w1_67
    s_mul_i32 s62, s52, 1769472
    s_add_u32 s62, s62, s64
    v_lshrrev_b32 v156, 4, v0
    v_mul_u32_u24 v156, 36864, v156
    v_and_b32 v155, 15, v0
    v_lshl_add_u32 v156, v155, 2, v156
    buffer_load_dword a120, v156, s[20:23], s62 offen
    s_add_u32 s62, s62, 9216
    buffer_load_dword a121, v156, s[20:23], s62 offen
    s_add_u32 s62, s62, 9216
    buffer_load_dword a122, v156, s[20:23], s62 offen
    s_add_u32 s62, s62, 9216
    buffer_load_dword a123, v156, s[20:23], s62 offen
    s_add_u32 s62, s62, 119808
    buffer_load_dword a124, v156, s[20:23], s62 offen
    s_add_u32 s62, s62, 9216
    buffer_load_dword a125, v156, s[20:23], s62 offen
    s_add_u32 s62, s62, 9216
    buffer_load_dword a126, v156, s[20:23], s62 offen
    s_add_u32 s62, s62, 9216
    buffer_load_dword a127, v156, s[20:23], s62 offen
    s_add_u32 s62, s62, 119808
    buffer_load_dword a128, v156, s[20:23], s62 offen
    s_add_u32 s62, s62, 9216
    buffer_load_dword a129, v156, s[20:23], s62 offen
    s_add_u32 s62, s62, 9216
    buffer_load_dword a130, v156, s[20:23], s62 offen
    s_add_u32 s62, s62, 9216
    buffer_load_dword a131, v156, s[20:23], s62 offen
    s_add_u32 s62, s62, 119808
    buffer_load_dword a132, v156, s[20:23], s62 offen
    s_add_u32 s62, s62, 9216
    buffer_load_dword a133, v156, s[20:23], s62 offen
    s_add_u32 s62, s62, 9216
    buffer_load_dword a134, v156, s[20:23], s62 offen
    s_add_u32 s62, s62, 9216
    buffer_load_dword a135, v156, s[20:23], s62 offen
    s_add_u32 s62, s62, 119808
    buffer_load_dword a136, v156, s[20:23], s62 offen
    s_add_u32 s62, s62, 9216
    buffer_load_dword a137, v156, s[20:23], s62 offen
    s_add_u32 s62, s62, 9216
    buffer_load_dword a138, v156, s[20:23], s62 offen
    s_add_u32 s62, s62, 9216
    buffer_load_dword a139, v156, s[20:23], s62 offen
    s_add_u32 s62, s62, 119808
    buffer_load_dword a140, v156, s[20:23], s62 offen
    s_add_u32 s62, s62, 9216
    buffer_load_dword a141, v156, s[20:23], s62 offen
    s_add_u32 s62, s62, 9216
    buffer_load_dword a142, v156, s[20:23], s62 offen
    s_add_u32 s62, s62, 9216
    buffer_load_dword a143, v156, s[20:23], s62 offen
    s_add_u32 s62, s62, 119808
    buffer_load_dword a144, v156, s[20:23], s62 offen
    s_add_u32 s62, s62, 9216
    buffer_load_dword a145, v156, s[20:23], s62 offen
    s_add_u32 s62, s62, 9216
    buffer_load_dword a146, v156, s[20:23], s62 offen
    s_add_u32 s62, s62, 9216
    buffer_load_dword a147, v156, s[20:23], s62 offen
    s_add_u32 s62, s62, 119808
    buffer_load_dword a148, v156, s[20:23], s62 offen
    s_add_u32 s62, s62, 9216
    buffer_load_dword a149, v156, s[20:23], s62 offen
    s_add_u32 s62, s62, 9216
    buffer_load_dword a150, v156, s[20:23], s62 offen
    s_add_u32 s62, s62, 9216
    buffer_load_dword a151, v156, s[20:23], s62 offen
    s_add_u32 s62, s62, 119808
    buffer_load_dword a152, v156, s[20:23], s62 offen
    s_add_u32 s62, s62, 9216
    buffer_load_dword a153, v156, s[20:23], s62 offen
    s_add_u32 s62, s62, 9216
    buffer_load_dword a154, v156, s[20:23], s62 offen
    s_add_u32 s62, s62, 9216
    buffer_load_dword a155, v156, s[20:23], s62 offen
    s_add_u32 s62, s62, 119808
    buffer_load_dword a156, v156, s[20:23], s62 offen
    s_add_u32 s62, s62, 9216
    buffer_load_dword a157, v156, s[20:23], s62 offen
    s_add_u32 s62, s62, 9216
    buffer_load_dword a158, v156, s[20:23], s62 offen
    s_add_u32 s62, s62, 9216
    buffer_load_dword a159, v156, s[20:23], s62 offen
    s_add_u32 s62, s62, 119808
    buffer_load_dword a160, v156, s[20:23], s62 offen
    s_add_u32 s62, s62, 9216
    buffer_load_dword a161, v156, s[20:23], s62 offen
    s_add_u32 s62, s62, 9216
    buffer_load_dword a162, v156, s[20:23], s62 offen
    s_add_u32 s62, s62, 9216
    buffer_load_dword a163, v156, s[20:23], s62 offen
    s_add_u32 s62, s62, 119808
    buffer_load_dword a164, v156, s[20:23], s62 offen
    s_add_u32 s62, s62, 9216
    buffer_load_dword a165, v156, s[20:23], s62 offen
    s_add_u32 s62, s62, 9216
    buffer_load_dword a166, v156, s[20:23], s62 offen
    s_add_u32 s62, s62, 9216
    buffer_load_dword a167, v156, s[20:23], s62 offen
L_w1_67:
L_m0c:
    s_waitcnt vmcnt(0)
    v_lshlrev_b32 v32, 16, v32
L_m1:
    v_mov_b32 v64, 0
    v_mov_b32 v65, 0
    v_mov_b32 v66, 0
    v_mov_b32 v67, 0
    v_mov_b32 v68, 0
    v_mov_b32 v69, 0
    v_mov_b32 v70, 0
    v_mov_b32 v71, 0
    v_mov_b32 v157, 0xc0135761
    v_add_u32 v159, 4608, v22
    s_mul_i32 s62, s60, 4608
    s_add_u32 s62, s62, s56
    s_add_u32 s62, s62, 111104
    s_cmp_eq_u32 s60, 0
    s_cbranch_scc1 L_m1b
    s_add_u32 s67, s56, 118020
    s_mov_b64 exec, 1
.p2align 4
L_poll_68:
    buffer_load_dword v172, v2, s[28:31], s67 offen sc1
    s_sub_u32 s58, s58, 1
    s_cbranch_scc1 L_to_69
    s_waitcnt vmcnt(0)
    v_cmp_eq_u32 vcc, -1, v172
    s_cbranch_vccnz L_poll_68
L_ok_70:
    s_mov_b64 exec, -1
L_m1b:
    s_lshl_b32 s63, s60, 10
    s_add_u32 s63, s63, s56
    s_add_u32 s63, s63, 118144
    v_lshrrev_b32 v158, 5, v0
    v_lshlrev_b32 v158, 3, v158
    s_cmp_eq_u32 s52, 3
    s_cbranch_scc1 L_m2
    s_mov_b32 exec_lo, 0x00330033
    s_mov_b32 exec_hi, 0x00330033
    buffer_load_dwordx4 v[40:43], v7, s[28:31], s62 offen offset:0 sc1
    buffer_load_dwordx4 v[44:47], v7, s[28:31], s62 offen offset:64 sc1
    buffer_load_dwordx4 v[48:51], v7, s[28:31], s62 offen offset:128 sc1
    buffer_load_dwordx4 v[52:55], v7, s[28:31], s62 offen offset:192 sc1
    buffer_load_dwordx4 v[56:59], v7, s[28:31], s62 offen offset:256 sc1
    buffer_load_dwordx4 v[60:63], v7, s[28:31], s62 offen offset:320 sc1
    s_mov_b64 exec, -1
    s_mov_b32 exec_lo, 0x00330033
    s_mov_b32 exec_hi, 0x00330033
.p2align 4
L_poll_71:
    s_waitcnt vmcnt(0)
    v_smfmac_f32_16x16x64_bf16 v[64:67], v[40:43], a[120:127], v3
    buffer_load_dwordx4 v[40:43], v7, s[28:31], s62 offen offset:0 sc1
    v_smfmac_f32_16x16x64_bf16 v[64:67], v[44:47], a[128:135], v3
    buffer_load_dwordx4 v[44:47], v7, s[28:31], s62 offen offset:64 sc1
    v_smfmac_f32_16x16x64_bf16 v[64:67], v[48:51], a[136:143], v3
    buffer_load_dwordx4 v[48:51], v7, s[28:31], s62 offen offset:128 sc1
    v_smfmac_f32_16x16x64_bf16 v[64:67], v[52:55], a[144:151], v3
    buffer_load_dwordx4 v[52:55], v7, s[28:31], s62 offen offset:192 sc1
    v_smfmac_f32_16x16x64_bf16 v[64:67], v[56:59], a[152:159], v3
    buffer_load_dwordx4 v[56:59], v7, s[28:31], s62 offen offset:256 sc1
    v_smfmac_f32_16x16x64_bf16 v[64:67], v[60:63], a[160:167], v3
    buffer_load_dwordx4 v[60:63], v7, s[28:31], s62 offen offset:320 sc1
    s_nop 6
    v_cmp_u_f32 vcc, v64, v65
    s_cbranch_vccnz L_retry_72
L_ok_73:
    s_mov_b64 exec, -1
    s_mov_b32 exec_hi, 0
    ds_write_b128 v23, v[64:67]
    s_mov_b32 exec_hi, -1
    s_branch L_m2b
L_m2:
.p2align 4
L_poll_75:
    buffer_load_dwordx4 v[136:139], v35, s[28:31], s62 offen sc1
    buffer_load_dwordx4 v[140:143], v35, s[28:31], s62 offen offset:512 sc1
    buffer_load_dword v144, v36, s[28:31], s62 offen offset:1024 sc1
    s_sub_u32 s58, s58, 1
    s_cbranch_scc1 L_to_76
    s_waitcnt vmcnt(0)
    v_max3_u32 v175, v136, v137, v138
    v_max3_u32 v175, v175, v139, v140
    v_max3_u32 v175, v175, v141, v142
    v_max3_u32 v175, v175, v143, v144
    v_cmp_eq_u32 vcc, -1, v175
    s_cbranch_vccnz L_poll_75
L_ok_77:
    v_mov_b32 v152, 0
    v_mov_b32 v153, 0
    v_dot2c_f32_bf16 v152, v136, v39
    v_dot2c_f32_bf16 v153, v136, v136
    v_dot2c_f32_bf16 v152, v137, v39
    v_dot2c_f32_bf16 v153, v137, v137
    v_dot2c_f32_bf16 v152, v138, v39
    v_dot2c_f32_bf16 v153, v138, v138
    v_dot2c_f32_bf16 v152, v139, v39
    v_dot2c_f32_bf16 v153, v139, v139
    v_dot2c_f32_bf16 v152, v140, v39
    v_dot2c_f32_bf16 v153, v140, v140
    v_dot2c_f32_bf16 v152, v141, v39
    v_dot2c_f32_bf16 v153, v141, v141
    v_dot2c_f32_bf16 v152, v142, v39
    v_dot2c_f32_bf16 v153, v142, v142
    v_dot2c_f32_bf16 v152, v143, v39
    v_dot2c_f32_bf16 v153, v143, v143
    v_dot2c_f32_bf16 v152, v144, v39
    v_dot2c_f32_bf16 v153, v144, v144
    s_nop 2
    v_permlane16_swap_b32 v152, v153
    v_add_f32 v152, v152, v153
    s_nop 1
    v_add_f32_dpp v152, v152, v152 row_ror:8 row_mask:0xf bank_mask:0xf
    s_nop 1
    v_add_f32_dpp v152, v152, v152 row_ror:4 row_mask:0xf bank_mask:0xf
    s_nop 1
    v_add_f32_dpp v152, v152, v152 row_ror:2 row_mask:0xf bank_mask:0xf
    s_nop 1
    v_add_f32_dpp v152, v152, v152 row_ror:1 row_mask:0xf bank_mask:0xf
    v_mul_f32 v153, 0x3ae38e39, v152
    v_mul_f32 v152, 0x3ae38e39, v152
    s_nop 1
    v_permlane16_swap_b32 v152, v153
    v_fma_f32 v153, -v152, v152, v153
    v_max_f32 v153, 0, v153
    v_cvt_pk_bf16_f32 v153, v152, v153
    v_lshlrev_b32 v152, 16, v153
    v_and_b32 v153, 0xffff0000, v153
    v_add_f32 v153, 0x3727c5ac, v153
    v_cvt_pk_bf16_f32 v153, v153, v153
    v_and_b32 v153, 0xffff0000, v153
    v_sqrt_f32 v153, v153
    s_nop 0
    v_cvt_pk_bf16_f32 v153, v153, v153
    v_and_b32 v153, 0xffff0000, v153
    v_rcp_f32 v153, v153
    s_nop 0
    ds_write_b64 v158, v[152:153] offset:512
L_m2b:
    s_waitcnt lgkmcnt(0)
    s_barrier
    ds_read2_b32 v[164:165], v38 offset0:0 offset1:2
    ds_read2_b32 v[166:167], v38 offset0:128 offset1:130
    ds_read_b32 v168, v38 offset:1024
    ds_read_b32 v169, v38 offset:1032
    ds_read_b64 v[152:153], v158 offset:512
    v_mov_b32 v64, 0
    v_mov_b32 v65, 0
    v_mov_b32 v66, 0
    v_mov_b32 v67, 0
    s_waitcnt lgkmcnt(0)
    v_add_f32 v164, v164, v166
    v_add_f32 v165, v165, v167
    v_add_f32 v164, v164, v168
    v_add_f32 v165, v165, v169
    v_fma_f32 v164, -v152, v165, v164
    v_mul_f32 v164, v164, v153
    v_cvt_pk_bf16_f32 v164, v164, v164
    v_and_b32 v164, 0xffff0000, v164
    v_add_f32 v164, v164, v32
    v_cvt_pk_bf16_f32 v164, v164, v164
    v_and_b32 v164, 0xffff0000, v164
    v_mul_f32 v156, v164, v164
    v_fmac_f32 v157, 0xbdd2d3e8, v156
    v_mul_f32 v156, v157, v164
    v_exp_f32 v156, v156
    s_nop 0
    v_add_f32 v156, 1.0, v156
    v_rcp_f32 v156, v156
    s_nop 0
    v_mul_f32 v156, v156, v164
    v_cvt_pk_bf16_f32 v156, v156, 0
    ds_write2_b32 v13, v156, v156 offset1:5
    ds_read_b128 v[76:79], v14 offset:0
    ds_read_b128 v[80:83], v14 offset:128
    ds_read_b128 v[84:87], v14 offset:256
    ds_read_b128 v[88:91], v14 offset:384
    s_waitcnt lgkmcnt(3)
    v_smfmac_f32_16x16x64_bf16 v[64:67], v[76:79], a[168:175], v5
    s_waitcnt lgkmcnt(2)
    v_smfmac_f32_16x16x64_bf16 v[64:67], v[80:83], a[176:183], v5
    s_waitcnt lgkmcnt(1)
    v_smfmac_f32_16x16x64_bf16 v[64:67], v[84:87], a[184:191], v5
    s_waitcnt lgkmcnt(0)
    v_smfmac_f32_16x16x64_bf16 v[64:67], v[88:91], a[192:199], v5
    s_cmp_lg_u32 s52, 3
    s_cbranch_scc1 L_t_78
    v_smfmac_f32_16x16x64_bf16 v[68:71], v[76:79], a[120:127], v5
    v_smfmac_f32_16x16x64_bf16 v[68:71], v[80:83], a[128:135], v5
    v_smfmac_f32_16x16x64_bf16 v[68:71], v[84:87], a[136:143], v5
    v_smfmac_f32_16x16x64_bf16 v[68:71], v[88:91], a[144:151], v5
L_t_78:
    s_nop 0
    s_nop 4
    v_cvt_pk_bf16_f32 v64, v64, v65
    v_cvt_pk_bf16_f32 v65, v66, v67
    buffer_store_dwordx2 v[64:65], v22, s[28:31], s55 offen
    s_cmp_lg_u32 s59, 0
    s_cbranch_scc1 L_slow_80
L_back_81:
    s_cmp_lg_u32 s52, 3
    s_cbranch_scc1 L_t_79
    v_cvt_pk_bf16_f32 v68, v68, v69
    v_cvt_pk_bf16_f32 v69, v70, v71
    s_mov_b64 exec, s[68:69]
    buffer_store_dwordx2 v[68:69], v159, s[28:31], s55 offen
    s_cmp_lg_u32 s59, 0
    s_cbranch_scc1 L_slow_82
L_back_83:
    s_mov_b64 exec, -1
L_t_79:
L_m4:
L_next:
    s_cmp_lg_u32 s60, 0
    s_cbranch_scc1 L_fin
    s_mov_b32 s60, 1
    s_add_u32 s57, s56, 113408
    v_add_u32 v15, 2048, v15
    v_add_u32 v17, 2048, v17
    v_add_u32 v24, 2048, v24
    v_bfe_u32 v156, v8, 1, 8
    v_and_b32 v8, 0xfffffe00, v8
    v_add_u32 v8, v8, v156
    v_bfe_u32 v156, v9, 1, 8
    v_and_b32 v9, 0xfffffe00, v9
    v_add_u32 v9, v9, v156
    v_add_u32 v92, 4096, v9
    s_branch L_layer
L_out:
    buffer_store_dword v156, v34, s[36:39], 0 offen
    s_mov_b32 s62, 9445376
    s_mov_b64 exec, 1
    buffer_store_dword v174, v2, s[28:31], s62 offen
L_fin:
L_end:
    s_endpgm
L_probe:
    s_cmp_lt_u32 s54, 20
    s_cbranch_scc1 L_next
    s_cmp_lg_u32 s60, 0
    s_cbranch_scc1 L_next
    s_sub_u32 s62, s54, 20
    s_lshl_b32 s62, s62, 18
    s_lshl_b32 s63, s53, 10
    s_add_u32 s62, s62, s63
    s_add_u32 s62, s62, 6488064
    s_add_u32 s4, s28, s62
    s_addc_u32 s5, s29, 0
    s_mov_b32 s64, -1
    s_mov_b32 s65, -1
    s_mov_b32 s66, 3
L_pr1:
    s_memtime s[6:7]
    s_waitcnt lgkmcnt(0)
    s_load_dword s67, s[4:5], 0 glc
    s_waitcnt lgkmcnt(0)
    s_memtime s[8:9]
    s_waitcnt lgkmcnt(0)
    s_load_dword s67, s[4:5], 0x2000 glc
    s_waitcnt lgkmcnt(0)
    s_memtime s[10:11]
    s_waitcnt lgkmcnt(0)
    s_sub_u32 s62, s8, s6
    s_sub_u32 s63, s10, s8
    s_min_u32 s64, s64, s62
    s_min_u32 s65, s65, s63
    s_sub_u32 s66, s66, 1
    s_cmp_lg_u32 s66, 0
    s_cbranch_scc1 L_pr1
    s_cmp_lt_u32 s65, s64
    s_cselect_b32 s62, 0x2000, 0
    v_mov_b32 v156, 0
    v_mov_b32 v155, s62
    ds_write_b32 v156, v155 offset:8176
    s_branch L_next
L_af2:
    s_cmp_eq_u32 s59, 1499136
    s_cbranch_scc1 L_g2
    s_add_u32 s59, s59, 1
    s_lshl_b32 s64, s53, 10
    s_add_u32 s64, s64, 9437184
    s_lshl_b32 s66, s60, 2
    s_add_u32 s63, s66, s64
    s_cmp_lt_u32 s59, 40
    s_cbranch_scc1 L_af5
    s_mov_b64 exec, 1
    buffer_store_dword v174, v2, s[28:31], s63 offen sc1
    s_mov_b32 exec_lo, -1
    buffer_load_dwordx4 v[148:151], v2, s[28:31], s64 offen sc1
    s_mov_b32 exec_hi, -1
    s_waitcnt vmcnt(0)
    v_xor_b32 v175, s43, v148
    v_bitop3_b32 v175, v175, v149, s43 bitop3:0xf6
    v_bitop3_b32 v175, v175, v150, s43 bitop3:0xf6
    v_bitop3_b32 v175, v175, v151, s43 bitop3:0xf6
    v_and_b32 v156, 0x0fffffff, v175
    v_cmp_ne_u32 vcc, 0, v156
    s_nop 0
    s_cmp_lg_u32 vcc_lo, 0
    s_cbranch_scc1 L_af5
    v_cmp_ne_u32 vcc, 0, v175
    s_nop 0
    s_cmp_lg_u32 vcc_lo, 0
    s_cbranch_scc1 L_spread
L_af5:
    s_sub_u32 s58, s58, 1
    s_cbranch_scc0 L_g4
    s_mov_b32 s58, 0
    s_mov_b32 s59, 0
    s_branch L_g2
L_spread:
    s_mov_b32 s59, 1499136
    s_add_u32 s56, s55, 1499136
    s_mul_i32 s67, s60, 944
    s_add_u32 s67, s67, s56
    s_mov_b32 exec_hi, 134217727
    buffer_store_dwordx4 v[176:179], v2, s[28:31], s67 offen sc1
    s_mov_b32 exec_hi, -1
    s_mov_b32 exec_hi, 0
    buffer_store_dwordx4 v[64:67], v8, s[28:31], s56 offen sc1
L_sp0:
    s_waitcnt vmcnt(0)
    s_mov_b64 exec, 1
    buffer_store_dword v174, v2, s[28:31], s63 offen offset:512 sc1
    s_mov_b32 exec_lo, -1
L_sp1:
    s_mov_b32 exec_hi, 0
    buffer_load_dwordx4 v[148:151], v2, s[28:31], s64 offen offset:512 sc1
    s_mov_b32 exec_hi, -1
    s_waitcnt vmcnt(0)
    v_xor_b32 v175, s43, v148
    v_bitop3_b32 v175, v175, v149, s43 bitop3:0xf6
    v_bitop3_b32 v175, v175, v150, s43 bitop3:0xf6
    v_bitop3_b32 v175, v175, v151, s43 bitop3:0xf6
    v_and_b32 v175, 0x0fffffff, v175
    v_cmp_ne_u32 vcc, 0, v175
    s_nop 0
    s_cmp_eq_u32 vcc_lo, 0
    s_cbranch_scc1 L_g4
    s_sleep 4
    s_sub_u32 s58, s58, 1
    s_cbranch_scc0 L_sp1
    s_mov_b32 s58, 0
    s_waitcnt vmcnt(0) lgkmcnt(0)
    s_branch L_g4
L_g5:
    s_sub_u32 s58, s58, 1
    s_cbranch_scc0 L_g4
    s_mov_b32 s58, 0
    s_waitcnt vmcnt(0) lgkmcnt(0)
    s_branch L_g3
L_to_3:
    s_mov_b32 s58, 0
    s_waitcnt vmcnt(0) lgkmcnt(0)
    s_branch L_ok_4
L_retry_6:
    s_mov_b64 exec, -1
    v_mov_b32 v64, 0
    v_mov_b32 v65, 0
    v_mov_b32 v66, 0
    v_mov_b32 v67, 0
    s_mov_b32 exec_lo, 0x00330033
    s_mov_b32 exec_hi, 0x00330033
    s_sub_u32 s58, s58, 1
    s_cbranch_scc1 L_nan_8
    s_and_b32 s67, s58, 15
    s_cbranch_scc1 L_poll_5
    v_max3_u32 v175, v40, v41, v42
    v_max3_u32 v175, v175, v43, v44
    v_max3_u32 v175, v175, v45, v46
    v_max3_u32 v175, v175, v47, v48
    v_max3_u32 v175, v175, v49, v50
    v_max_u32 v175, v175, v51
    v_cmp_eq_u32 vcc, -1, v175
    s_cbranch_vccnz L_poll_5
L_nan_8:
    s_max_i32 s58, s58, 0
    v_smfmac_f32_16x16x64_bf16 v[64:67], v[40:43], a[0:7], v3
    v_smfmac_f32_16x16x64_bf16 v[64:67], v[44:47], a[8:15], v3
    v_smfmac_f32_16x16x64_bf16 v[64:67], v[48:51], a[16:23], v3
    s_nop 7
    s_branch L_ok_7
L_slow_9:
    buffer_store_dwordx2 v[64:65], v8, s[28:31], s56 offen sc1
    s_nop 1
    s_branch L_back_10
L_to_12:
    s_mov_b32 s58, 0
    s_waitcnt vmcnt(0) lgkmcnt(0)
    s_branch L_ok_13
L_more_17:
.p2align 4
L_poll_14:
    buffer_load_dwordx2 v[196:197], v9, s[28:31], s56 offen offset:0 sc1
    buffer_load_dwordx2 v[200:201], v9, s[28:31], s56 offen offset:2048 sc1
    buffer_load_dwordx2 v[204:205], v92, s[28:31], s56 offen offset:0 sc1
    buffer_load_dwordx2 v[208:209], v92, s[28:31], s56 offen offset:2048 sc1
    s_sub_u32 s58, s58, 1
    s_cbranch_scc1 L_to_15
    s_waitcnt vmcnt(0)
    v_or3_b32 v175, v196, v197, v200
    v_or3_b32 v175, v175, v201, v204
    v_or3_b32 v175, v175, v205, v208
    v_bitop3_b32 v175, v175, v209, 1 bitop3:0xa8
    v_cmp_ne_u32 vcc, 0, v175
    s_cbranch_vccnz L_poll_14
    s_branch L_ok_16
L_to_15:
    s_mov_b32 s58, 0
    s_waitcnt vmcnt(0) lgkmcnt(0)
    s_branch L_ok_16
L_slow_18:
    buffer_store_dword v152, v15, s[28:31], s56 offen sc1
    s_nop 1
    s_branch L_back_19
L_slow_20:
    buffer_store_dwordx2 v[72:73], v16, s[28:31], s56 offen sc1
    s_nop 1
    s_branch L_back_21
L_to_23:
    s_mov_b32 s58, 0
    s_waitcnt vmcnt(0) lgkmcnt(0)
    s_branch L_ok_24
L_more_28:
    buffer_load_dwordx2 v[188:189], v18, s[28:31], s56 offen offset:0 sc1
    buffer_load_dwordx2 v[190:191], v18, s[28:31], s56 offen offset:512 sc1
    s_sleep 2
.p2align 4
L_poll_25:
    buffer_load_dwordx2 v[188:189], v18, s[28:31], s56 offen offset:0 sc1
    buffer_load_dwordx2 v[190:191], v18, s[28:31], s56 offen offset:512 sc1
    s_sub_u32 s58, s58, 1
    s_cbranch_scc1 L_to_26
    s_waitcnt vmcnt(2)
    v_max3_u32 v175, v188, v189, v190
    v_max_u32 v175, v175, v191
    v_cmp_eq_u32 vcc, -1, v175
    s_cbranch_vccnz L_poll_25
    s_branch L_ok_27
L_to_26:
    s_mov_b32 s58, 0
    s_waitcnt vmcnt(0) lgkmcnt(0)
    s_branch L_ok_27
L_slow_29:
    buffer_store_dwordx2 v[176:177], v18, s[28:31], s56 offen offset:0 sc1
    buffer_store_dwordx2 v[176:177], v18, s[28:31], s56 offen offset:512 sc1
    s_nop 1
    s_branch L_back_30
L_slow_33:
    buffer_store_dwordx2 v[64:65], v21, s[28:31], s56 offen sc1
    s_nop 1
    s_branch L_back_34
L_slow_35:
    buffer_store_dwordx2 v[68:69], v159, s[28:31], s56 offen sc1
    s_nop 1
    s_branch L_back_36
L_to_38:
    s_mov_b32 s58, 0
    s_waitcnt vmcnt(0) lgkmcnt(0)
    s_branch L_ok_39
L_slow_40:
    buffer_store_dwordx2 v[176:177], v25, s[28:31], s56 offen offset:0 sc1
    buffer_store_dwordx2 v[176:177], v25, s[28:31], s56 offen offset:512 sc1
    s_nop 1
    s_branch L_back_41
L_slow_43:
    buffer_store_dword v2, v156, s[28:31], s56 offen sc1
    s_nop 1
    s_branch L_back_44
L_to_46:
    s_mov_b32 s58, 0
    s_waitcnt vmcnt(0) lgkmcnt(0)
    s_branch L_ok_47
L_slow_48:
    buffer_store_dword v156, v29, s[28:31], s56 offen sc1
    s_nop 1
    s_branch L_back_49
L_to_51:
    s_mov_b32 s58, 0
    s_waitcnt vmcnt(0) lgkmcnt(0)
    s_branch L_ok_52
L_slow_53:
    buffer_store_dwordx2 v[176:177], v25, s[28:31], s56 offen offset:0 sc1
    buffer_store_dwordx2 v[176:177], v25, s[28:31], s56 offen offset:512 sc1
    s_mov_b64 exec, 0xffff
    buffer_store_dwordx2 v[176:177], v25, s[28:31], s56 offen offset:1024 sc1
    s_mov_b64 exec, -1
    s_nop 1
    s_branch L_back_54
L_slow_56:
    buffer_store_dword v2, v156, s[28:31], s56 offen sc1
    s_nop 1
    s_branch L_back_57
L_to_59:
    s_mov_b32 s58, 0
    s_waitcnt vmcnt(0) lgkmcnt(0)
    s_branch L_ok_60
L_slow_61:
    buffer_store_dword v156, v29, s[28:31], s56 offen sc1
    s_nop 1
    s_branch L_back_62
L_slow_63:
    buffer_store_dword v156, v93, s[28:31], s56 offen sc1
    s_nop 1
    s_branch L_back_64
L_to_69:
    s_mov_b32 s58, 0
    s_waitcnt vmcnt(0) lgkmcnt(0)
    s_branch L_ok_70
L_retry_72:
    s_mov_b64 exec, -1
    v_mov_b32 v64, 0
    v_mov_b32 v65, 0
    v_mov_b32 v66, 0
    v_mov_b32 v67, 0
    s_mov_b32 exec_lo, 0x00330033
    s_mov_b32 exec_hi, 0x00330033
    s_sub_u32 s58, s58, 1
    s_cbranch_scc1 L_nan_74
    s_and_b32 s67, s58, 15
    s_cbranch_scc1 L_poll_71
    v_max3_u32 v175, v40, v41, v42
    v_max3_u32 v175, v175, v43, v44
    v_max3_u32 v175, v175, v45, v46
    v_max3_u32 v175, v175, v47, v48
    v_max3_u32 v175, v175, v49, v50
    v_max3_u32 v175, v175, v51, v52
    v_max3_u32 v175, v175, v53, v54
    v_max3_u32 v175, v175, v55, v56
    v_max3_u32 v175, v175, v57, v58
    v_max3_u32 v175, v175, v59, v60
    v_max3_u32 v175, v175, v61, v62
    v_max_u32 v175, v175, v63
    v_cmp_eq_u32 vcc, -1, v175
    s_cbranch_vccnz L_poll_71
L_nan_74:
    s_max_i32 s58, s58, 0
    v_smfmac_f32_16x16x64_bf16 v[64:67], v[40:43], a[120:127], v3
    v_smfmac_f32_16x16x64_bf16 v[64:67], v[44:47], a[128:135], v3
    v_smfmac_f32_16x16x64_bf16 v[64:67], v[48:51], a[136:143], v3
    v_smfmac_f32_16x16x64_bf16 v[64:67], v[52:55], a[144:151], v3
    v_smfmac_f32_16x16x64_bf16 v[64:67], v[56:59], a[152:159], v3
    v_smfmac_f32_16x16x64_bf16 v[64:67], v[60:63], a[160:167], v3
    s_nop 7
    s_branch L_ok_73
L_to_76:
    s_mov_b32 s58, 0
    s_waitcnt vmcnt(0) lgkmcnt(0)
    s_branch L_ok_77
L_slow_80:
    buffer_store_dwordx2 v[64:65], v22, s[28:31], s56 offen sc1
    s_nop 1
    s_branch L_back_81
L_slow_82:
    buffer_store_dwordx2 v[68:69], v159, s[28:31], s56 offen sc1
    s_nop 1
    s_branch L_back_83
L_codeend:
.section .rodata,"a"
.p2align 6
.amdhsa_kernel interleave_layers__sliding_block_cached__dense_activation_gelu__decode_kernel
  .amdhsa_next_free_vgpr 444
  .amdhsa_next_free_sgpr 102
  .amdhsa_accum_offset 212
  .amdhsa_group_segment_fixed_size 0
  .amdhsa_kernarg_size 104
  .amdhsa_user_sgpr_count 2
  .amdhsa_user_sgpr_kernarg_segment_ptr 1
  .amdhsa_system_sgpr_workgroup_id_x 1
.end_amdhsa_kernel
```
